```python
import torch

def _softmax(x, axis=-1):
    return torch.softmax(x, dim=axis)

def _gelu(x):
    return torch.nn.functional.gelu(x, approximate='tanh')

def _silu(x):
    return torch.nn.functional.silu(x)

def _sigmoid(x):
    return torch.sigmoid(x)

def _layernorm(x, axis=-1, eps=1e-05):
    m = x.mean(dim=axis, keepdim=True)
    v = x.var(dim=axis, keepdim=True, unbiased=False)
    return (x - m) / torch.sqrt(v + eps)

def _scatter_add(tgt, idx, src, axis=0):
    return tgt.clone().index_add_(axis, idx, src)

def _segment_sum(src, seg, n):
    out = torch.zeros((n,) + src.shape[1:], dtype=src.dtype)
    return out.index_add_(0, seg, src)

def _pad(x, pw):
    flat = tuple((v for pair in reversed(pw) for v in pair))
    return torch.nn.functional.pad(x, flat)
kernel_name = 'adaLN_cond__sliding_block_cached__mixer_token_mlp__decode'

def setup_inputs():

    _w = lambda a: (lambda t: t.to(torch.bfloat16) if t.is_floating_point() else t)(torch.as_tensor(a))

    def _A_setup():
        B, Sq, D = (1, 1, 576)
        Hq, Hkv, Sk, Dh = (32, 16, 8192, 128)
        assert Hq % Hkv == 0, (Hq, Hkv)
        return {'x': _w((lambda *s: torch.randn(*s, dtype=torch.bfloat16) * 0.05)(B, Sq, D)), 'k_cache': _w((lambda *s: torch.randn(*s, dtype=torch.bfloat16) * 1.6)(B, Hkv, Sk, Dh)), 'v_cache': _w((lambda *s: torch.randn(*s, dtype=torch.bfloat16) * 1.6)(B, Hkv, Sk, Dh)), 'wq': _w((lambda *s: torch.randn(*s, dtype=torch.bfloat16) * 1.6)(D, Hq * Dh) * D ** (-0.5)), 'wo': _w((lambda *s: torch.randn(*s, dtype=torch.bfloat16) * 1.6)(Hq * Dh, D) * (Hq * Dh) ** (-0.5))}
    _A_in = _A_setup()

    def _B_setup():
        B, S, D, F = (1, 1, 576, 4608)
        return {'x': _w((lambda *s: torch.randn(*s, dtype=torch.bfloat16) * 0.05)(B, S, D)), 'w1': _w((lambda *s: torch.randn(*s, dtype=torch.bfloat16) * 1.6)(S, F) * S ** (-0.5)), 'b1': _w((lambda *s: torch.randn(*s, dtype=torch.bfloat16) * 1.6)(F) * 0.02), 'w2': _w((lambda *s: torch.randn(*s, dtype=torch.bfloat16) * 1.6)(F, S) * F ** (-0.5)), 'b2': _w((lambda *s: torch.randn(*s, dtype=torch.bfloat16) * 1.6)(S) * 0.02)}
    _B_in = _B_setup()
    return {'A_x': _A_in['x'], 'A_k_cache': _A_in['k_cache'], 'A_v_cache': _A_in['v_cache'], 'A_wq': _A_in['wq'], 'A_wo': _A_in['wo'], 'B_x': _B_in['x'], 'B_w1': _B_in['w1'], 'B_b1': _B_in['b1'], 'B_w2': _B_in['w2'], 'B_b2': _B_in['b2'], 'c': _w((lambda *s: torch.randn(*s, dtype=torch.bfloat16) * 0.05)(1, 576) * 8.0), 'w_mod': _w((lambda *s: torch.randn(*s, dtype=torch.bfloat16) * 0.05)(576, 6 * 576) * 576 ** (-0.5) * 8.0)}

def reference(A_x, A_k_cache, A_v_cache, A_wq, A_wo, B_x, B_w1, B_b1, B_w2, B_b2, c, w_mod):

    def _A_ref(x, k_cache, v_cache, wq, wo):
        B, Sq, D = x.shape
        Hq, Dh = (32, 128)
        Hkv, Sk = (k_cache.shape[1], k_cache.shape[2])
        W = min(4096, max(256, Sk // 4))
        rep = Hq // Hkv
        q = (lambda x, *d: x.permute(*d))((x @ wq).reshape(B, Sq, Hq, Dh), 0, 2, 1, 3)
        k = (lambda x, n, axis: torch.repeat_interleave(x, n, dim=axis))(k_cache[:, :, Sk - W:, :], rep, axis=1)
        v = (lambda x, n, axis: torch.repeat_interleave(x, n, dim=axis))(v_cache[:, :, Sk - W:, :], rep, axis=1)
        scores = torch.einsum('bhqd,bhkd->bhqk', q, k) * Dh ** (-0.5)
        p = _softmax(scores, axis=-1)
        o = torch.einsum('bhqk,bhkd->bhqd', p, v)
        return (lambda x, *d: x.permute(*d))(o, 0, 2, 1, 3).reshape(B, Sq, Hq * Dh) @ wo

    def _B_ref(x, w1, b1, w2, b2):
        B, S, D = x.shape
        h = _layernorm(x, axis=-1)
        u = torch.einsum('bsd,sf->bdf', h, w1) + b1
        u = _gelu(u)
        y = torch.einsum('bdf,fs->bds', u, w2) + b2
        return (lambda x, *d: x.permute(*d))(y, 0, 2, 1)
    x = A_x
    mod = (_silu(c) @ w_mod).reshape(c.shape[0], 6, 1, -1)
    sa, ca, ga, sb, cb, gb = (mod[:, 0].clone(), mod[:, 1].clone(), mod[:, 2].clone(), mod[:, 3].clone(), mod[:, 4].clone(), mod[:, 5].clone())
    h = _layernorm(x, axis=-1) * (1 + ca) + sa
    x = x + ga * _A_ref(h, A_k_cache, A_v_cache, A_wq, A_wo)
    h = _layernorm(x, axis=-1) * (1 + cb) + sb
    x = x + gb * _B_ref(h, B_w1, B_b1, B_w2, B_b2)
    return x
```

```asm
; @launch grid=(512,1,1) block=(512,1,1) lds=77824
.amdgcn_target "amdgcn-amd-amdhsa--gfx950"
.text
.globl adaLN_cond__sliding_block_cached__mixer_token_mlp__decode_kernel
.p2align 8
.type adaLN_cond__sliding_block_cached__mixer_token_mlp__decode_kernel,@function
adaLN_cond__sliding_block_cached__mixer_token_mlp__decode_kernel:
    s_cmp_ge_u32 s2, 512
    s_cbranch_scc1 L_end
    s_load_dwordx16 s[16:31], s[0:1], 0
    s_load_dwordx8 s[32:39], s[0:1], 64
    s_load_dwordx4 s[40:43], s[0:1], 96
    s_load_dwordx2 s[44:45], s[0:1], 112
    v_lshrrev_b32 v2, 6, v0
    v_and_b32 v1, 63, v0
    v_readfirstlane_b32 s3, v2
    s_mov_b32 s71, 65536
    s_cmp_lt_u32 s2, 16
    s_cselect_b32 s65, s3, 0
    s_cmp_lt_u32 s65, 5
    s_cbranch_scc1 L_nopf
    s_getpc_b64 s[60:61]
L_pc:
    s_sub_u32 s65, s65, 5
    s_lshl_b32 s65, s65, 13
    v_lshl_add_u32 v4, v1, 7, s65
    v_min_u32 v4, L_codeend-L_pc-4, v4
    global_load_dword v127, v4, s[60:61]
L_nopf:
    s_cmp_ge_u32 s2, 256
    s_cbranch_scc1 L_T
    s_setprio 2
    s_lshr_b32 s5, s2, 4
    s_lshl_b32 s5, s5, 3
    s_and_b32 s65, s2, 7
    s_or_b32 s5, s5, s65
    s_mov_b32 s72, 0x05040100
    s_mov_b32 s73, 0x07060302
    s_bitcmp1_b32 s2, 3
    s_cbranch_scc1 L_S
    s_cmp_ge_u32 s3, 4
    s_cbranch_scc1 L_CB
    s_cmp_eq_u32 s3, 0
    s_cbranch_scc0 L_CA
    s_cmp_lt_u32 s2, 8
    s_cbranch_scc0 L_CB
    s_memrealtime s[62:63]
    v_mov_b32 v18, 0
    v_mov_b32 v19, 0
    s_waitcnt lgkmcnt(0)
    s_or_b32 s63, s63, 0x80000000
    v_mov_b32 v16, s62
    v_mov_b32 v17, s63
    s_mov_b64 exec, 1
    global_atomic_cmpswap_x2 v18, v[16:19], s[42:43] sc1
    s_mov_b64 exec, -1
    s_branch L_CB
L_CA:
    s_sub_u32 s70, s3, 1
    s_and_b32 s78, s5, 7
    s_lshr_b32 s79, s5, 3
    s_lshl_b32 s65, s78, 3
    s_and_b32 s66, s79, 7
    s_add_u32 s65, s65, s66
    s_add_u32 s66, s65, 32
    s_cmp_ge_u32 s79, 8
    s_cselect_b32 s74, s65, s66
    s_cmp_lt_u32 s78, 4
    s_cselect_b32 s74, s74, 64
    s_mul_i32 s67, s74, 3641
    s_lshr_b32 s67, s67, 16
    s_mul_i32 s65, s67, 18
    s_sub_u32 s68, s74, s65
    v_lshrrev_b32 v2, 3, v1
    v_mul_u32_u24 v2, 55296, v2
    v_and_b32 v3, 7, v1
    v_lshl_add_u32 v9, v3, 4, v2
    v_lshlrev_b32 v11, 4, v1
    v_lshrrev_b32 v2, 4, v1
    v_and_b32 v3, 1, v1
    v_lshlrev_b32 v2, 5, v2
    v_lshl_add_u32 v13, v3, 4, v2
    v_and_b32 v2, 7, v1
    v_lshlrev_b32 v2, 5, v2
    v_bfe_u32 v3, v1, 3, 1
    v_lshl_add_u32 v10, v3, 4, v2
    s_lshl_b32 s66, s70, 8
    s_add_u32 s66, s66, 10240
    v_add_u32 v10, s66, v10
    s_waitcnt lgkmcnt(0)
    s_mov_b32 s52, s38
    s_mov_b32 s53, s39
    s_mov_b32 s54, 0x3cc000
    s_mov_b32 s55, 0x00020000
    s_cmp_lt_u32 s74, 54
    s_cbranch_scc0 L_CAc_none
    s_mul_i32 s69, s67, 3
    s_add_u32 s69, s69, s70
    s_lshl_b32 s65, s69, 7
    v_lshl_add_u32 v4, v1, 1, s65
    global_load_ushort v7, v4, s[36:37]
    s_mul_i32 s65, s69, 442368
    s_lshl_b32 s66, s68, 7
    s_add_u32 s65, s65, s66
    v_add_u32 v4, s65, v9
    buffer_load_dwordx4 v[64:67], v4, s[52:55], 0 offen offset:0 nt
    s_mov_b32 s64, 6912
    buffer_load_dwordx4 v[68:71], v4, s[52:55], s64 offen nt
    s_mov_b32 s64, 13824
    buffer_load_dwordx4 v[72:75], v4, s[52:55], s64 offen nt
    s_mov_b32 s64, 20736
    buffer_load_dwordx4 v[76:79], v4, s[52:55], s64 offen nt
    s_mov_b32 s64, 27648
    buffer_load_dwordx4 v[80:83], v4, s[52:55], s64 offen nt
    s_mov_b32 s64, 34560
    buffer_load_dwordx4 v[84:87], v4, s[52:55], s64 offen nt
    s_mov_b32 s64, 41472
    buffer_load_dwordx4 v[88:91], v4, s[52:55], s64 offen nt
    s_mov_b32 s64, 48384
    buffer_load_dwordx4 v[92:95], v4, s[52:55], s64 offen nt
    s_mov_b32 s48, s44
    s_mov_b32 s49, s45
    s_mov_b32 s50, 0x10000000
    s_mov_b32 s51, 0x00020000
    s_barrier
    s_mul_i32 s60, s68, 3
    s_add_u32 s60, s60, s67
    s_lshl_b32 s60, s60, 9
    s_waitcnt vmcnt(8)
    v_lshlrev_b32 v7, 16, v7
    v_mul_f32 v2, 0xbfb8aa3b, v7
    v_exp_f32 v2, v2
    s_nop 0
    v_add_f32 v2, 1.0, v2
    v_rcp_f32 v2, v2
    s_nop 0
    v_mul_f32 v2, v7, v2
    v_cvt_pk_bf16_f32 v2, v2, v2
    s_lshl_b32 s65, s3, 7
    s_add_u32 s65, s65, 512
    v_lshl_add_u32 v3, v1, 1, s65
    ds_write_b16 v3, v2
    v_add_u32 v3, s65, v13
    ds_read_b128 v[16:19], v3
    s_waitcnt vmcnt(6)
    v_perm_b32 v96, v68, v64, s72
    v_perm_b32 v100, v68, v64, s73
    v_perm_b32 v104, v69, v65, s72
    v_perm_b32 v108, v69, v65, s73
    v_perm_b32 v112, v70, v66, s72
    v_perm_b32 v116, v70, v66, s73
    v_perm_b32 v120, v71, v67, s72
    v_perm_b32 v124, v71, v67, s73
    s_waitcnt vmcnt(4)
    v_perm_b32 v97, v76, v72, s72
    v_perm_b32 v101, v76, v72, s73
    v_perm_b32 v105, v77, v73, s72
    v_perm_b32 v109, v77, v73, s73
    v_perm_b32 v113, v78, v74, s72
    v_perm_b32 v117, v78, v74, s73
    v_perm_b32 v121, v79, v75, s72
    v_perm_b32 v125, v79, v75, s73
    s_waitcnt vmcnt(2)
    v_perm_b32 v98, v84, v80, s72
    v_perm_b32 v102, v84, v80, s73
    v_perm_b32 v106, v85, v81, s72
    v_perm_b32 v110, v85, v81, s73
    v_perm_b32 v114, v86, v82, s72
    v_perm_b32 v118, v86, v82, s73
    v_perm_b32 v122, v87, v83, s72
    v_perm_b32 v126, v87, v83, s73
    s_waitcnt vmcnt(0)
    s_waitcnt lgkmcnt(0)
    s_load_dwordx2 s[6:7], s[42:43], 0
    v_perm_b32 v99, v92, v88, s72
    v_perm_b32 v103, v92, v88, s73
    v_perm_b32 v107, v93, v89, s72
    v_perm_b32 v111, v93, v89, s73
    v_perm_b32 v115, v94, v90, s72
    v_perm_b32 v119, v94, v90, s73
    v_perm_b32 v123, v95, v91, s72
    v_perm_b32 v127, v95, v91, s73
    v_mfma_f32_16x16x32_bf16 v[32:35], v[16:19], v[96:99], 0
    v_mfma_f32_16x16x32_bf16 v[48:51], v[16:19], v[112:115], 0
    v_mfma_f32_16x16x32_bf16 v[36:39], v[16:19], v[100:103], 0
    v_mfma_f32_16x16x32_bf16 v[52:55], v[16:19], v[116:119], 0
    v_mfma_f32_16x16x32_bf16 v[40:43], v[16:19], v[104:107], 0
    v_mfma_f32_16x16x32_bf16 v[56:59], v[16:19], v[120:123], 0
    v_mfma_f32_16x16x32_bf16 v[44:47], v[16:19], v[108:111], 0
    v_mfma_f32_16x16x32_bf16 v[60:63], v[16:19], v[124:127], 0
    s_nop 1
    v_add_f32_dpp v20, v33, v32 row_ror:8 row_mask:0xf bank_mask:0x3
    v_add_f32_dpp v20, v48, v49 row_ror:8 row_mask:0xf bank_mask:0xc
    v_add_f32_dpp v21, v37, v36 row_ror:8 row_mask:0xf bank_mask:0x3
    v_add_f32_dpp v21, v52, v53 row_ror:8 row_mask:0xf bank_mask:0xc
    v_add_f32_dpp v22, v41, v40 row_ror:8 row_mask:0xf bank_mask:0x3
    v_add_f32_dpp v22, v56, v57 row_ror:8 row_mask:0xf bank_mask:0xc
    v_add_f32_dpp v23, v45, v44 row_ror:8 row_mask:0xf bank_mask:0x3
    v_add_f32_dpp v23, v60, v61 row_ror:8 row_mask:0xf bank_mask:0xc
    s_mov_b64 exec, 0xffff
    ds_write_b128 v10, v[20:23] offset:0
    s_mov_b64 exec, -1
    v_mov_b32 v2, 1668
    v_mov_b32 v3, 1
    s_mov_b64 exec, 1
    ds_add_rtn_u32 v3, v2, v3
    s_mov_b64 exec, -1
    s_waitcnt lgkmcnt(0)
    v_readfirstlane_b32 s64, v3
    s_add_u32 s64, s64, 1
    s_cmp_eq_u32 s64, 3
    s_cbranch_scc0 L_CAc_done
    v_lshlrev_b32 v4, 3, v1
    ds_read_b64 v[64:65], v4 offset:10240
    ds_read_b64 v[68:69], v4 offset:10496
    ds_read_b64 v[72:73], v4 offset:10752
    s_cmp_lg_u32 s7, 0
    s_cbranch_scc1 L_CAc_epok
    s_load_dwordx2 s[6:7], s[42:43], 0 glc
    s_waitcnt lgkmcnt(0)
    s_cmp_lg_u32 s7, 0
    s_cbranch_scc1 L_CAc_epok
    v_mov_b32 v2, 0
    global_load_dwordx2 v[14:15], v2, s[42:43] sc1
    s_waitcnt vmcnt(0)
L_CAc_ep:
    v_readfirstlane_b32 s7, v15
    v_readfirstlane_b32 s6, v14
    s_cmp_lg_u32 s7, 0
    s_cbranch_scc1 L_CAc_epok
    s_sub_u32 s71, s71, 1
    s_cmp_lt_i32 s71, 0
    s_cbranch_scc1 L_CAc_epok
    v_mov_b32 v2, 0
    global_load_dwordx2 v[14:15], v2, s[42:43] sc1
    s_waitcnt vmcnt(0)
    s_branch L_CAc_ep
L_CAc_epok:
    s_waitcnt lgkmcnt(0)
    v_pk_add_f32 v[64:65], v[64:65], v[68:69]
    v_pk_add_f32 v[64:65], v[64:65], v[72:73]
    v_mov_b32 v66, s6
    v_mov_b32 v67, s7
    s_mov_b32 exec_hi, 0
    buffer_store_dwordx4 v[64:67], v11, s[48:51], s60 offen sc1
    s_mov_b64 exec, -1
L_CAc_done:
    s_branch L_CAc_done2
L_CAc_none:
    s_barrier
L_CAc_done2:
    s_mov_b32 s48, s44
    s_mov_b32 s49, s45
    s_mov_b32 s50, 0x10000000
    s_mov_b32 s51, 0x00020000
    s_cmp_eq_u32 s5, 127
    s_cbranch_scc1 L_E0
    v_mov_b32 v2, 0
    global_load_dwordx2 v[14:15], v2, s[42:43] sc1
    s_mul_i32 s74, s78, 14
    s_add_u32 s74, s74, s79
    s_cmp_lt_u32 s79, 14
    s_cselect_b32 s74, s74, 255
    s_mul_i32 s67, s74, 1821
    s_lshr_b32 s67, s67, 16
    s_mul_i32 s68, s67, 36
    s_sub_u32 s68, s74, s68
    s_mul_i32 s61, s67, 9216
    s_lshl_b32 s64, s68, 8
    s_add_u32 s61, s61, s64
    s_add_u32 s61, s61, 479232
    s_add_u32 s68, s68, 18
    s_cmp_eq_u32 s78, 7
    s_cselect_b32 s65, 12, 14
    s_cselect_b32 s66, 3, 2
    s_add_u32 s75, s79, s66
    s_cmp_ge_u32 s79, s65
    s_cselect_b32 s75, s75, 255
    s_cmp_lt_u32 s75, 18
    s_cselect_b32 s75, s75, 255
    s_cmp_eq_u32 s3, 1
    s_cbranch_scc0 L_CA_b2
    v_mov_b32 v32, -1
    v_mov_b32 v33, -1
    v_mov_b32 v34, -1
    v_mov_b32 v35, -1
    s_lshl_b32 s60, s5, 8
    s_add_u32 s60, s60, 589824
    s_mov_b64 exec, 0xffff
    s_cmp_ge_u32 s79, 9
    s_cselect_b32 s65, 9, 0
    s_cselect_b32 s66, 1, 0
    s_sub_u32 s76, s79, s65
    s_add_u32 s77, s78, s66
    s_add_u32 s77, s77, s78
    s_mul_i32 s63, s77, 2304
    s_lshl_b32 s64, s76, 8
    s_add_u32 s63, s63, s64
    s_add_u32 s63, s63, 442368
    buffer_store_dwordx4 v[32:35], v11, s[48:51], s63 offen sc1
    s_cmp_ge_u32 s75, 9
    s_cselect_b32 s65, 9, 0
    s_cselect_b32 s66, 1, 0
    s_sub_u32 s76, s75, s65
    s_add_u32 s77, s78, s66
    s_add_u32 s77, s77, s78
    s_mul_i32 s63, s77, 2304
    s_lshl_b32 s64, s76, 8
    s_add_u32 s63, s63, s64
    s_add_u32 s63, s63, 442368
    s_cmp_lt_u32 s75, 18
    s_cselect_b32 s66, s63, s60
    buffer_store_dwordx4 v[32:35], v11, s[48:51], s66 offen sc1
    s_cmp_lt_u32 s74, 108
    s_cselect_b32 s66, s61, s60
    buffer_store_dwordx4 v[32:35], v11, s[48:51], s66 offen sc1
    s_mov_b64 exec, -1
    s_lshl_b32 s62, s5, 3
    s_add_u32 s62, s62, 507904
    s_waitcnt vmcnt(0)
L_CA1_ep:
    v_readfirstlane_b32 s7, v15
    v_readfirstlane_b32 s6, v14
    s_cmp_lg_u32 s7, 0
    s_cbranch_scc1 L_CA1_epok
    s_sub_u32 s71, s71, 1
    s_cmp_lt_i32 s71, 0
    s_cbranch_scc1 L_CA1_epok
    s_sleep 2
    v_mov_b32 v2, 0
    global_load_dwordx2 v[14:15], v2, s[42:43] sc1
    s_waitcnt vmcnt(0)
    s_branch L_CA1_ep
L_CA1_epok:
    s_mov_b64 exec, 1
    buffer_store_dwordx2 v[14:15], v11, s[48:51], s62 offen sc1
    s_mov_b64 exec, -1
    s_branch L_CA_b1
L_CA_b2:
    s_waitcnt vmcnt(0)
L_CA2_ep:
    v_readfirstlane_b32 s7, v15
    v_readfirstlane_b32 s6, v14
    s_cmp_lg_u32 s7, 0
    s_cbranch_scc1 L_CA2_epok
    s_sub_u32 s71, s71, 1
    s_cmp_lt_i32 s71, 0
    s_cbranch_scc1 L_CA2_epok
    s_sleep 2
    v_mov_b32 v2, 0
    global_load_dwordx2 v[14:15], v2, s[42:43] sc1
    s_waitcnt vmcnt(0)
    s_branch L_CA2_ep
L_CA2_epok:
L_CA_b1:
    s_barrier
    s_cmp_lt_u32 s75, 18
    s_cbranch_scc1 L_D
    s_cmp_lt_u32 s74, 108
    s_cbranch_scc0 L_fin
    s_mul_i32 s69, s67, 3
    s_add_u32 s69, s69, s70
    s_lshl_b32 s65, s69, 7
    v_lshl_add_u32 v4, v1, 1, s65
    global_load_ushort v7, v4, s[36:37]
    s_mul_i32 s65, s69, 442368
    s_lshl_b32 s66, s68, 7
    s_add_u32 s65, s65, s66
    v_add_u32 v4, s65, v9
    buffer_load_dwordx4 v[64:67], v4, s[52:55], 0 offen offset:0 nt
    s_mov_b32 s64, 6912
    buffer_load_dwordx4 v[68:71], v4, s[52:55], s64 offen nt
    s_mov_b32 s64, 13824
    buffer_load_dwordx4 v[72:75], v4, s[52:55], s64 offen nt
    s_mov_b32 s64, 20736
    buffer_load_dwordx4 v[76:79], v4, s[52:55], s64 offen nt
    s_mov_b32 s64, 27648
    buffer_load_dwordx4 v[80:83], v4, s[52:55], s64 offen nt
    s_mov_b32 s64, 34560
    buffer_load_dwordx4 v[84:87], v4, s[52:55], s64 offen nt
    s_mov_b32 s64, 41472
    buffer_load_dwordx4 v[88:91], v4, s[52:55], s64 offen nt
    s_mov_b32 s64, 48384
    buffer_load_dwordx4 v[92:95], v4, s[52:55], s64 offen nt
    s_waitcnt vmcnt(8)
    v_lshlrev_b32 v7, 16, v7
    v_mul_f32 v2, 0xbfb8aa3b, v7
    v_exp_f32 v2, v2
    s_nop 0
    v_add_f32 v2, 1.0, v2
    v_rcp_f32 v2, v2
    s_nop 0
    v_mul_f32 v2, v7, v2
    v_cvt_pk_bf16_f32 v2, v2, v2
    s_lshl_b32 s65, s3, 7
    s_add_u32 s65, s65, 512
    v_lshl_add_u32 v3, v1, 1, s65
    ds_write_b16 v3, v2
    v_add_u32 v3, s65, v13
    ds_read_b128 v[16:19], v3
    s_waitcnt vmcnt(6)
    v_perm_b32 v96, v68, v64, s72
    v_perm_b32 v100, v68, v64, s73
    v_perm_b32 v104, v69, v65, s72
    v_perm_b32 v108, v69, v65, s73
    v_perm_b32 v112, v70, v66, s72
    v_perm_b32 v116, v70, v66, s73
    v_perm_b32 v120, v71, v67, s72
    v_perm_b32 v124, v71, v67, s73
    s_waitcnt vmcnt(4)
    v_perm_b32 v97, v76, v72, s72
    v_perm_b32 v101, v76, v72, s73
    v_perm_b32 v105, v77, v73, s72
    v_perm_b32 v109, v77, v73, s73
    v_perm_b32 v113, v78, v74, s72
    v_perm_b32 v117, v78, v74, s73
    v_perm_b32 v121, v79, v75, s72
    v_perm_b32 v125, v79, v75, s73
    s_waitcnt vmcnt(2)
    v_perm_b32 v98, v84, v80, s72
    v_perm_b32 v102, v84, v80, s73
    v_perm_b32 v106, v85, v81, s72
    v_perm_b32 v110, v85, v81, s73
    v_perm_b32 v114, v86, v82, s72
    v_perm_b32 v118, v86, v82, s73
    v_perm_b32 v122, v87, v83, s72
    v_perm_b32 v126, v87, v83, s73
    s_waitcnt vmcnt(0)
    v_perm_b32 v99, v92, v88, s72
    v_perm_b32 v103, v92, v88, s73
    v_perm_b32 v107, v93, v89, s72
    v_perm_b32 v111, v93, v89, s73
    v_perm_b32 v115, v94, v90, s72
    v_perm_b32 v119, v94, v90, s73
    v_perm_b32 v123, v95, v91, s72
    v_perm_b32 v127, v95, v91, s73
    s_waitcnt lgkmcnt(0)
    v_mfma_f32_16x16x32_bf16 v[32:35], v[16:19], v[96:99], 0
    v_mfma_f32_16x16x32_bf16 v[48:51], v[16:19], v[112:115], 0
    v_mfma_f32_16x16x32_bf16 v[36:39], v[16:19], v[100:103], 0
    v_mfma_f32_16x16x32_bf16 v[52:55], v[16:19], v[116:119], 0
    v_mfma_f32_16x16x32_bf16 v[40:43], v[16:19], v[104:107], 0
    v_mfma_f32_16x16x32_bf16 v[56:59], v[16:19], v[120:123], 0
    v_mfma_f32_16x16x32_bf16 v[44:47], v[16:19], v[108:111], 0
    v_mfma_f32_16x16x32_bf16 v[60:63], v[16:19], v[124:127], 0
    s_nop 1
    v_add_f32_dpp v20, v33, v32 row_ror:8 row_mask:0xf bank_mask:0x3
    v_add_f32_dpp v20, v48, v49 row_ror:8 row_mask:0xf bank_mask:0xc
    v_add_f32_dpp v21, v37, v36 row_ror:8 row_mask:0xf bank_mask:0x3
    v_add_f32_dpp v21, v52, v53 row_ror:8 row_mask:0xf bank_mask:0xc
    v_add_f32_dpp v22, v41, v40 row_ror:8 row_mask:0xf bank_mask:0x3
    v_add_f32_dpp v22, v56, v57 row_ror:8 row_mask:0xf bank_mask:0xc
    v_add_f32_dpp v23, v45, v44 row_ror:8 row_mask:0xf bank_mask:0x3
    v_add_f32_dpp v23, v60, v61 row_ror:8 row_mask:0xf bank_mask:0xc
    s_mov_b64 exec, 0xffff
    ds_write_b128 v10, v[20:23] offset:768
    s_mov_b64 exec, -1
    v_mov_b32 v2, 1672
    v_mov_b32 v3, 1
    s_mov_b64 exec, 1
    ds_add_rtn_u32 v3, v2, v3
    s_mov_b64 exec, -1
    s_waitcnt lgkmcnt(0)
    v_readfirstlane_b32 s64, v3
    s_add_u32 s64, s64, 1
    s_cmp_eq_u32 s64, 3
    s_cbranch_scc0 L_fin_done
    ds_read_b128 v[64:67], v11 offset:11008
    ds_read_b128 v[68:71], v11 offset:11264
    ds_read_b128 v[72:75], v11 offset:11520
    s_waitcnt lgkmcnt(0)
    v_pk_add_f32 v[64:65], v[64:65], v[68:69]
    v_pk_add_f32 v[66:67], v[66:67], v[70:71]
    v_pk_add_f32 v[64:65], v[64:65], v[72:73]
    v_pk_add_f32 v[66:67], v[66:67], v[74:75]
    v_min_u32 v64, 0xfffffffe, v64
    v_min_u32 v65, 0xfffffffe, v65
    v_min_u32 v66, 0xfffffffe, v66
    v_min_u32 v67, 0xfffffffe, v67
    s_mov_b64 exec, 0xffff
    buffer_store_dwordx4 v[64:67], v11, s[48:51], s61 offen offset:0 sc1
    s_mov_b64 exec, -1
    s_branch L_fin
L_CB:
    s_and_b32 s78, s5, 7
    s_lshr_b32 s79, s5, 3
    s_add_u32 s69, s3, 4
    s_and_b32 s69, s69, 7
    s_lshr_b32 s74, s79, 3
    s_sub_u32 s75, 5, s74
    s_lshl_b32 s67, s74, 11
    s_mul_i32 s74, s74, 5
    s_add_u32 s74, s74, s69
    v_lshrrev_b32 v2, 3, v1
    v_mul_u32_u24 v2, 65536, v2
    v_and_b32 v3, 7, v1
    v_lshl_add_u32 v9, v3, 4, v2
    s_and_b32 s66, s79, 1
    s_add_u32 s66, s66, s78
    s_add_u32 s66, s66, s78
    s_lshl_b32 s66, s66, 2
    s_bfe_u32 s68, s79, 0x20001
    s_add_u32 s66, s66, s68
    s_lshl_b32 s65, s74, 19
    s_lshl_b32 s64, s66, 7
    s_add_u32 s65, s65, s64
    s_lshr_b32 s64, s66, 2
    s_lshl_b32 s64, s64, 12
    s_add_u32 s67, s67, s64
    s_lshl_b32 s64, s68, 9
    s_add_u32 s67, s67, s64
    s_add_u32 s67, s67, 131072
    v_add_u32 v9, s65, v9
    v_lshlrev_b32 v11, 4, v1
    v_lshrrev_b32 v2, 4, v1
    v_and_b32 v3, 1, v1
    v_lshlrev_b32 v2, 5, v2
    v_lshl_add_u32 v13, v3, 4, v2
    v_and_b32 v2, 31, v1
    v_lshlrev_b32 v8, 2, v2
    s_lshl_b32 s65, s74, 7
    v_add_u32 v5, s65, v8
    s_cmp_eq_u32 s3, 0
    s_cbranch_scc0 L_CB_b0
    v_mov_b32 v6, 0
    v_mov_b32 v7, 0
    v_mov_b32 v4, 1664
    ds_write_b64 v4, v[6:7]
    ds_write_b64 v4, v[6:7] offset:8
    ds_write_b32 v4, v6 offset:16
    v_lshlrev_b32 v4, 2, v1
    ds_write_b32 v4, v6 offset:7168
L_CB_b0:
    s_waitcnt lgkmcnt(0)
    s_barrier
    s_cmp_lt_u32 s69, s75
    s_cbranch_scc0 L_CB_noB
    s_mov_b32 s52, s22
    s_mov_b32 s53, s23
    s_mov_b32 s54, 0x480000
    s_mov_b32 s55, 0x00020000
    buffer_load_dwordx4 v[64:67], v9, s[52:55], 0 offen offset:0 nt
    s_mov_b32 s64, 8192
    buffer_load_dwordx4 v[68:71], v9, s[52:55], s64 offen nt
    s_mov_b32 s64, 16384
    buffer_load_dwordx4 v[72:75], v9, s[52:55], s64 offen nt
    s_mov_b32 s64, 24576
    buffer_load_dwordx4 v[76:79], v9, s[52:55], s64 offen nt
    s_mov_b32 s64, 32768
    buffer_load_dwordx4 v[80:83], v9, s[52:55], s64 offen nt
    s_mov_b32 s64, 40960
    buffer_load_dwordx4 v[84:87], v9, s[52:55], s64 offen nt
    s_mov_b32 s64, 49152
    buffer_load_dwordx4 v[88:91], v9, s[52:55], s64 offen nt
    s_mov_b32 s64, 57344
    buffer_load_dwordx4 v[92:95], v9, s[52:55], s64 offen nt
    v_mov_b32 v2, 0
    global_load_dwordx2 v[14:15], v2, s[42:43] sc1
    global_load_dwordx4 v[44:47], v11, s[16:17]
    global_load_dword v40, v8, s[16:17] offset:1024
    global_load_dword v42, v5, s[16:17]
L_CB_noB:
    s_mov_b32 s48, s44
    s_mov_b32 s49, s45
    s_mov_b32 s50, 0x10000000
    s_mov_b32 s51, 0x00020000
    v_and_b32 v2, 7, v1
    v_lshlrev_b32 v2, 5, v2
    v_bfe_u32 v3, v1, 3, 1
    v_lshl_add_u32 v12, v3, 4, v2
    s_lshl_b32 s66, s69, 8
    v_add_u32 v12, s66, v12
    s_cmp_lt_u32 s69, s75
    s_cbranch_scc0 L_CB_noB2
    v_lshrrev_b32 v3, 5, v1
    v_mul_u32_u24 v3, 13824, v3
    v_lshl_add_u32 v28, v8, 2, v3
    s_mul_i32 s15, s74, 1536
    s_lshl_b32 s65, s3, 7
    s_add_u32 s65, s65, 512
    v_add_u32 v8, s65, v8
    v_add_u32 v29, s65, v13
    s_waitcnt vmcnt(10)
    v_perm_b32 v96, v68, v64, s72
    v_perm_b32 v100, v68, v64, s73
    v_perm_b32 v104, v69, v65, s72
    v_perm_b32 v108, v69, v65, s73
    v_perm_b32 v112, v70, v66, s72
    v_perm_b32 v116, v70, v66, s73
    v_perm_b32 v120, v71, v67, s72
    v_perm_b32 v124, v71, v67, s73
    s_waitcnt vmcnt(8)
    v_perm_b32 v97, v76, v72, s72
    v_perm_b32 v101, v76, v72, s73
    v_perm_b32 v105, v77, v73, s72
    v_perm_b32 v109, v77, v73, s73
    v_perm_b32 v113, v78, v74, s72
    v_perm_b32 v117, v78, v74, s73
    v_perm_b32 v121, v79, v75, s72
    v_perm_b32 v125, v79, v75, s73
    s_waitcnt vmcnt(6)
    buffer_load_dwordx4 v[48:51], v28, s[48:51], s15 offen offset:0 sc1
    buffer_load_dwordx4 v[52:55], v28, s[48:51], s15 offen offset:512 sc1
    buffer_load_dwordx4 v[56:59], v28, s[48:51], s15 offen offset:1024 sc1
    v_perm_b32 v98, v84, v80, s72
    v_perm_b32 v102, v84, v80, s73
    v_perm_b32 v106, v85, v81, s72
    v_perm_b32 v110, v85, v81, s73
    v_perm_b32 v114, v86, v82, s72
    v_perm_b32 v118, v86, v82, s73
    v_perm_b32 v122, v87, v83, s72
    v_perm_b32 v126, v87, v83, s73
    s_waitcnt vmcnt(7)
    v_perm_b32 v99, v92, v88, s72
    v_perm_b32 v103, v92, v88, s73
    v_perm_b32 v107, v93, v89, s72
    v_perm_b32 v111, v93, v89, s73
    v_perm_b32 v115, v94, v90, s72
    v_perm_b32 v119, v94, v90, s73
    v_perm_b32 v123, v95, v91, s72
    v_perm_b32 v127, v95, v91, s73
    s_waitcnt vmcnt(3)
L_CB_ep:
    v_readfirstlane_b32 s7, v15
    v_readfirstlane_b32 s6, v14
    s_cmp_lg_u32 s7, 0
    s_cbranch_scc1 L_CB_epok
    s_sub_u32 s71, s71, 1
    s_cmp_lt_i32 s71, 0
    s_cbranch_scc1 L_CB_epok
    v_mov_b32 v2, 0
    global_load_dwordx2 v[14:15], v2, s[42:43] sc1
    s_waitcnt vmcnt(0)
    s_branch L_CB_ep
L_CB_epok:
    v_lshlrev_b32 v32, 16, v44
    v_and_b32 v33, 0xffff0000, v44
    v_lshlrev_b32 v34, 16, v45
    v_and_b32 v35, 0xffff0000, v45
    v_lshlrev_b32 v36, 16, v46
    v_and_b32 v37, 0xffff0000, v46
    v_lshlrev_b32 v38, 16, v47
    v_and_b32 v39, 0xffff0000, v47
    v_readfirstlane_b32 s14, v32
    v_and_b32 v41, 0xffff0000, v40
    v_lshlrev_b32 v40, 16, v40
    v_and_b32 v43, 0xffff0000, v42
    v_lshlrev_b32 v42, 16, v42
    v_subrev_f32 v32, s14, v32
    v_subrev_f32 v33, s14, v33
    v_subrev_f32 v34, s14, v34
    v_subrev_f32 v35, s14, v35
    v_subrev_f32 v36, s14, v36
    v_subrev_f32 v37, s14, v37
    v_subrev_f32 v38, s14, v38
    v_subrev_f32 v39, s14, v39
    v_subrev_f32 v40, s14, v40
    v_subrev_f32 v41, s14, v41
    s_mov_b32 exec_lo, 0
    v_mov_b32 v40, 0
    v_mov_b32 v41, 0
    s_mov_b32 exec_lo, -1
    v_mov_b32 v4, v32
    v_mul_f32 v5, v32, v32
    v_add_f32 v4, v4, v33
    v_fmac_f32 v5, v33, v33
    v_add_f32 v4, v4, v34
    v_fmac_f32 v5, v34, v34
    v_add_f32 v4, v4, v35
    v_fmac_f32 v5, v35, v35
    v_add_f32 v4, v4, v36
    v_fmac_f32 v5, v36, v36
    v_add_f32 v4, v4, v37
    v_fmac_f32 v5, v37, v37
    v_add_f32 v4, v4, v38
    v_fmac_f32 v5, v38, v38
    v_add_f32 v4, v4, v39
    v_fmac_f32 v5, v39, v39
    v_add_f32 v4, v4, v40
    v_fmac_f32 v5, v40, v40
    v_add_f32 v4, v4, v41
    v_fmac_f32 v5, v41, v41
    s_nop 0
    v_add_f32_dpp v4, v4, v4 row_ror:1 row_mask:0xf bank_mask:0xf
    v_add_f32_dpp v5, v5, v5 row_ror:1 row_mask:0xf bank_mask:0xf
    s_nop 0
    v_add_f32_dpp v4, v4, v4 row_ror:2 row_mask:0xf bank_mask:0xf
    v_add_f32_dpp v5, v5, v5 row_ror:2 row_mask:0xf bank_mask:0xf
    s_nop 0
    v_add_f32_dpp v4, v4, v4 row_ror:4 row_mask:0xf bank_mask:0xf
    v_add_f32_dpp v5, v5, v5 row_ror:4 row_mask:0xf bank_mask:0xf
    s_nop 0
    v_add_f32_dpp v4, v4, v4 row_ror:8 row_mask:0xf bank_mask:0xf
    v_add_f32_dpp v5, v5, v5 row_ror:8 row_mask:0xf bank_mask:0xf
    v_mov_b32 v2, v4
    v_mov_b32 v3, v5
    s_nop 0
    v_permlane16_swap_b32 v4, v2
    v_permlane16_swap_b32 v5, v3
    s_nop 0
    v_add_f32 v4, v4, v2
    v_add_f32 v5, v5, v3
    v_mov_b32 v2, v4
    v_mov_b32 v3, v5
    s_nop 0
    v_permlane32_swap_b32 v4, v2
    v_permlane32_swap_b32 v5, v3
    s_nop 0
    v_add_f32 v4, v4, v2
    v_add_f32 v5, v5, v3
    v_mul_f32 v4, 0x3ae38e39, v4
    v_mul_f32 v5, 0x3ae38e39, v5
    v_fma_f32 v5, -v4, v4, v5
    v_add_f32 v6, s14, v4
    v_max_f32 v5, 0, v5
    v_cvt_pk_bf16_f32 v5, 0, v5
    v_cvt_pk_bf16_f32 v6, 0, v6
    v_add_f32 v5, 0x3727c5ac, v5
    v_cvt_pk_bf16_f32 v5, 0, v5
    v_sqrt_f32 v5, v5
    s_nop 0
    v_cvt_pk_bf16_f32 v5, 0, v5
    v_rcp_f32 v7, v5
    s_nop 0
    v_sub_f32 v42, v42, v6
    v_sub_f32 v43, v43, v6
    v_cvt_pk_bf16_f32 v42, 0, v42
    v_cvt_pk_bf16_f32 v43, 0, v43
    v_mul_f32 v42, v42, v7
    v_mul_f32 v43, v43, v7
    v_cvt_pk_bf16_f32 v42, 0, v42
    v_cvt_pk_bf16_f32 v43, 0, v43
    v_mov_b32 v26, s6
    v_mov_b32 v27, s7
L_CB_p0:
    s_waitcnt vmcnt(0)
    v_xor_b32 v4, s6, v50
    v_xor_b32 v5, s7, v51
    v_bitop3_b32 v4, v4, v54, s6 bitop3:0xf6
    v_bitop3_b32 v5, v5, v55, s7 bitop3:0xf6
    v_bitop3_b32 v4, v4, v58, s6 bitop3:0xf6
    v_bitop3_b32 v5, v5, v59, s7 bitop3:0xf6
    v_or_b32 v4, v4, v5
    v_cmp_ne_u32 vcc, 0, v4
    s_cmp_eq_u64 vcc, 0
    s_cbranch_scc1 L_CB_ok0
    s_sub_u32 s71, s71, 1
    s_cmp_lt_i32 s71, 0
    s_cbranch_scc1 L_CB_ok0
    s_sleep 1
    buffer_load_dwordx4 v[48:51], v28, s[48:51], s15 offen offset:0 sc1
    buffer_load_dwordx4 v[52:55], v28, s[48:51], s15 offen offset:512 sc1
    buffer_load_dwordx4 v[56:59], v28, s[48:51], s15 offen offset:1024 sc1
    s_branch L_CB_p0
L_CB_ok0:
    v_pk_add_f32 v[48:49], v[48:49], v[52:53]
    v_pk_add_f32 v[48:49], v[48:49], v[56:57]
    v_cvt_pk_bf16_f32 v48, 0, v48
    v_cvt_pk_bf16_f32 v49, 0, v49
    v_mov_b32 v52, v48
    v_mov_b32 v53, v49
    s_nop 0
    v_permlane32_swap_b32 v48, v52
    v_permlane32_swap_b32 v49, v53
    s_nop 0
    v_add_f32 v52, 1.0, v52
    v_add_f32 v53, 1.0, v53
    v_cvt_pk_bf16_f32 v52, 0, v52
    v_cvt_pk_bf16_f32 v53, 0, v53
    v_mul_f32 v52, v52, v42
    v_mul_f32 v53, v53, v43
    v_cvt_pk_bf16_f32 v52, 0, v52
    v_cvt_pk_bf16_f32 v53, 0, v53
    v_add_f32 v52, v52, v48
    v_add_f32 v53, v53, v49
    v_cvt_pk_bf16_f32 v4, v52, v53
    ds_write_b32 v8, v4
    ds_read_b128 v[16:19], v29
    v_lshlrev_b32 v4, 3, v1
    s_waitcnt lgkmcnt(0)
    v_mfma_f32_16x16x32_bf16 v[32:35], v[16:19], v[96:99], 0
    v_mfma_f32_16x16x32_bf16 v[48:51], v[16:19], v[112:115], 0
    v_mfma_f32_16x16x32_bf16 v[36:39], v[16:19], v[100:103], 0
    v_mfma_f32_16x16x32_bf16 v[52:55], v[16:19], v[116:119], 0
    v_mfma_f32_16x16x32_bf16 v[40:43], v[16:19], v[104:107], 0
    v_mfma_f32_16x16x32_bf16 v[56:59], v[16:19], v[120:123], 0
    v_mfma_f32_16x16x32_bf16 v[44:47], v[16:19], v[108:111], 0
    v_mfma_f32_16x16x32_bf16 v[60:63], v[16:19], v[124:127], 0
    s_nop 1
    v_add_f32_dpp v20, v33, v32 row_ror:8 row_mask:0xf bank_mask:0x3
    v_add_f32_dpp v20, v48, v49 row_ror:8 row_mask:0xf bank_mask:0xc
    v_add_f32_dpp v21, v37, v36 row_ror:8 row_mask:0xf bank_mask:0x3
    v_add_f32_dpp v21, v52, v53 row_ror:8 row_mask:0xf bank_mask:0xc
    v_add_f32_dpp v22, v41, v40 row_ror:8 row_mask:0xf bank_mask:0x3
    v_add_f32_dpp v22, v56, v57 row_ror:8 row_mask:0xf bank_mask:0xc
    v_add_f32_dpp v23, v45, v44 row_ror:8 row_mask:0xf bank_mask:0x3
    v_add_f32_dpp v23, v60, v61 row_ror:8 row_mask:0xf bank_mask:0xc
    s_mov_b64 exec, 0xffff
    ds_write_b128 v12, v[20:23] offset:6144
    s_mov_b64 exec, -1
    v_mov_b32 v2, 1676
    v_mov_b32 v3, 1
    s_mov_b64 exec, 1
    ds_add_rtn_u32 v3, v2, v3
    s_mov_b64 exec, -1
    s_waitcnt lgkmcnt(0)
    v_readfirstlane_b32 s64, v3
    s_add_u32 s64, s64, 1
    s_cmp_eq_u32 s64, s75
    s_cbranch_scc0 L_CB_D
    ds_read_b64 v[32:33], v4 offset:6144
    ds_read_b64 v[34:35], v4 offset:6400
    ds_read_b64 v[36:37], v4 offset:6656
    ds_read_b64 v[38:39], v4 offset:6912
    ds_read_b64 v[40:41], v4 offset:7168
    s_waitcnt lgkmcnt(0)
    v_pk_add_f32 v[32:33], v[32:33], v[34:35]
    v_pk_add_f32 v[36:37], v[36:37], v[38:39]
    v_pk_add_f32 v[32:33], v[32:33], v[40:41]
    v_pk_add_f32 v[24:25], v[32:33], v[36:37]
    s_mov_b32 exec_hi, 0
    s_add_u32 s64, s67, 1048576
    buffer_store_dwordx4 v[24:27], v11, s[48:51], s64 offen
    buffer_store_dwordx4 v[24:27], v11, s[48:51], s67 offen sc1
    s_mov_b64 exec, -1
    s_branch L_CB_D
L_CB_noB2:
    v_mov_b32 v2, 0
    global_load_dwordx2 v[14:15], v2, s[42:43] sc1
    s_waitcnt vmcnt(0)
L_CB2_ep:
    v_readfirstlane_b32 s7, v15
    v_readfirstlane_b32 s6, v14
    s_cmp_lg_u32 s7, 0
    s_cbranch_scc1 L_CB2_epok
    s_sub_u32 s71, s71, 1
    s_cmp_lt_i32 s71, 0
    s_cbranch_scc1 L_CB2_epok
    s_sleep 2
    v_mov_b32 v2, 0
    global_load_dwordx2 v[14:15], v2, s[42:43] sc1
    s_waitcnt vmcnt(0)
    s_branch L_CB2_ep
L_CB2_epok:
L_CB_D:
    s_cmp_eq_u32 s5, 127
    s_cbranch_scc1 L_E0b
    s_mov_b32 s75, s79
    s_cmp_eq_u32 s3, 0
    s_cbranch_scc0 L_CB_t
    s_cmp_eq_u32 s78, 7
    s_cselect_b32 s65, 12, 14
    s_cselect_b32 s66, 3, 2
    s_add_u32 s75, s79, s66
    s_cmp_ge_u32 s79, s65
    s_cselect_b32 s75, s75, 255
    s_cmp_lt_u32 s75, 18
    s_cselect_b32 s75, s75, 255
L_CB_t:
    s_barrier
    s_cmp_lt_u32 s75, 18
    s_cbranch_scc0 L_fin
L_D:
    s_cmp_ge_u32 s75, 9
    s_cselect_b32 s65, 9, 0
    s_cselect_b32 s66, 1, 0
    s_sub_u32 s76, s75, s65
    s_add_u32 s77, s78, s66
    s_add_u32 s77, s77, s78
    s_and_b32 s69, s3, 3
    s_lshl_b32 s70, s77, 2
    s_add_u32 s70, s70, s69
    s_mov_b32 s56, s24
    s_mov_b32 s57, s25
    s_mov_b32 s58, 0x480000
    s_mov_b32 s59, 0x00020000
    v_lshrrev_b32 v2, 3, v1
    v_mul_u32_u24 v2, 9216, v2
    v_and_b32 v3, 7, v1
    v_lshl_add_u32 v10, v3, 4, v2
    s_mul_i32 s65, s70, 73728
    s_lshl_b32 s66, s76, 7
    s_add_u32 s65, s65, s66
    v_add_u32 v10, s65, v10
    buffer_load_dwordx4 v[64:67], v10, s[56:59], 0 offen offset:0 nt
    buffer_load_dwordx4 v[68:71], v10, s[56:59], 0 offen offset:1152 nt
    buffer_load_dwordx4 v[72:75], v10, s[56:59], 0 offen offset:2304 nt
    buffer_load_dwordx4 v[76:79], v10, s[56:59], 0 offen offset:3456 nt
    s_mov_b32 s64, 4608
    buffer_load_dwordx4 v[80:83], v10, s[56:59], s64 offen nt
    s_mov_b32 s64, 5760
    buffer_load_dwordx4 v[84:87], v10, s[56:59], s64 offen nt
    s_mov_b32 s64, 6912
    buffer_load_dwordx4 v[88:91], v10, s[56:59], s64 offen nt
    s_mov_b32 s64, 8064
    buffer_load_dwordx4 v[92:95], v10, s[56:59], s64 offen nt
    v_bfe_u32 v4, v1, 1, 3
    v_lshlrev_b32 v30, 3, v4
    s_lshl_b32 s60, s77, 6
    s_add_u32 s60, s60, 508928
    buffer_load_dwordx2 v[18:19], v30, s[48:51], s60 offen sc1
    v_lshlrev_b32 v31, 7, v4
    v_lshlrev_b32 v4, 9, v4
    v_lshl_add_u32 v9, v13, 1, v4
    v_and_b32 v2, 7, v1
    v_lshlrev_b32 v2, 5, v2
    v_bfe_u32 v3, v1, 3, 1
    v_lshl_add_u32 v12, v3, 4, v2
    s_lshl_b32 s66, s3, 8
    v_add_u32 v12, s66, v12
    s_and_b32 s74, s3, 4
    s_lshl_b32 s68, s74, 8
    v_add_u32 v8, s68, v11
    s_lshl_b32 s74, s74, 2
    s_sub_u32 s74, 1680, s74
    s_lshr_b32 s65, s70, 1
    s_lshl_b32 s66, s77, 10
    s_and_b32 s68, s65, 1
    s_lshl_b32 s68, s68, 3
    s_add_u32 s66, s66, s68
    s_add_u32 s61, s66, 1474560
    s_mov_b32 s12, 8
    s_lshl_b32 s65, s65, 12
    s_and_b32 s68, s70, 1
    s_lshl_b32 s68, s68, 8
    s_add_u32 s65, s65, s68
    s_add_u32 s62, s65, 1343488
    s_mul_i32 s63, s77, 2304
    s_lshl_b32 s64, s76, 8
    s_add_u32 s63, s63, s64
    s_add_u32 s63, s63, 442368
    s_waitcnt vmcnt(7)
    v_perm_b32 v96, v68, v64, s72
    v_perm_b32 v100, v68, v64, s73
    v_perm_b32 v104, v69, v65, s72
    v_perm_b32 v108, v69, v65, s73
    v_perm_b32 v112, v70, v66, s72
    v_perm_b32 v116, v70, v66, s73
    v_perm_b32 v120, v71, v67, s72
    v_perm_b32 v124, v71, v67, s73
    s_waitcnt vmcnt(5)
    v_perm_b32 v97, v76, v72, s72
    v_perm_b32 v101, v76, v72, s73
    v_perm_b32 v105, v77, v73, s72
    v_perm_b32 v109, v77, v73, s73
    v_perm_b32 v113, v78, v74, s72
    v_perm_b32 v117, v78, v74, s73
    v_perm_b32 v121, v79, v75, s72
    v_perm_b32 v125, v79, v75, s73
    s_waitcnt vmcnt(3)
    v_perm_b32 v98, v84, v80, s72
    v_perm_b32 v102, v84, v80, s73
    v_perm_b32 v106, v85, v81, s72
    v_perm_b32 v110, v85, v81, s73
    v_perm_b32 v114, v86, v82, s72
    v_perm_b32 v118, v86, v82, s73
    v_perm_b32 v122, v87, v83, s72
    v_perm_b32 v126, v87, v83, s73
    s_waitcnt vmcnt(1)
    v_perm_b32 v99, v92, v88, s72
    v_perm_b32 v103, v92, v88, s73
    v_perm_b32 v107, v93, v89, s72
    v_perm_b32 v111, v93, v89, s73
    v_perm_b32 v115, v94, v90, s72
    v_perm_b32 v119, v94, v90, s73
    v_perm_b32 v123, v95, v91, s72
    v_perm_b32 v127, v95, v91, s73
L_CB_fl:
    s_waitcnt vmcnt(0)
    v_cmp_ne_u64 vcc, s[6:7], v[18:19]
    s_cmp_eq_u64 vcc, 0
    s_cbranch_scc1 L_CB_flok
    s_sub_u32 s71, s71, 1
    s_cmp_lt_i32 s71, 0
    s_cbranch_scc1 L_CB_flok
    s_sleep 2
    buffer_load_dwordx2 v[18:19], v30, s[48:51], s60 offen sc1
    s_branch L_CB_fl
L_CB_flok:
L_CB_ml:
    s_xor_b32 s67, s61, 1048576
    s_xor_b32 s68, s62, 1048576
L_CB_poll:
    buffer_load_dwordx2 v[72:73], v31, s[48:51], s61 offen sc1
    buffer_load_dwordx4 v[64:67], v9, s[48:51], s62 offen sc1
    buffer_load_dwordx4 v[68:71], v9, s[48:51], s62 offen offset:16 sc1
    s_cmp_lt_i32 s12, 0
    s_cbranch_scc1 L_CB_poll2
    s_waitcnt vmcnt(0)
    v_max_f32_dpp v6, v72, v72 row_ror:2 row_mask:0xf bank_mask:0xf
    v_max3_u32 v4, v64, v65, v66
    v_max3_u32 v5, v67, v68, v69
    v_max_f32_dpp v6, v6, v6 row_ror:4 row_mask:0xf bank_mask:0xf
    v_max3_u32 v4, v4, v70, v71
    v_max3_u32 v5, v5, v72, v73
    v_max_f32_dpp v6, v6, v6 row_ror:8 row_mask:0xf bank_mask:0xf
    v_max_u32 v4, v4, v5
    v_cmp_eq_u32 vcc, -1, v4
    v_sub_f32 v6, v72, v6
    s_cmp_eq_u64 vcc, 0
    s_cbranch_scc1 L_CB_ok
    s_sub_u32 s12, s12, 1
    s_sleep 1
    s_branch L_CB_poll
L_CB_poll2:
    buffer_load_dwordx2 v[84:85], v31, s[48:51], s67 offen sc1
    buffer_load_dwordx4 v[76:79], v9, s[48:51], s68 offen sc1
    buffer_load_dwordx4 v[80:83], v9, s[48:51], s68 offen offset:16 sc1
    s_waitcnt vmcnt(0)
    v_min_u32 v64, v64, v76
    v_min_u32 v65, v65, v77
    v_min_u32 v66, v66, v78
    v_min_u32 v67, v67, v79
    v_min_u32 v68, v68, v80
    v_min_u32 v69, v69, v81
    v_min_u32 v70, v70, v82
    v_min_u32 v71, v71, v83
    v_min_u32 v72, v72, v84
    v_min_u32 v73, v73, v85
    s_nop 0
    v_max_f32_dpp v6, v72, v72 row_ror:2 row_mask:0xf bank_mask:0xf
    v_max3_u32 v4, v64, v65, v66
    v_max3_u32 v5, v67, v68, v69
    v_max_f32_dpp v6, v6, v6 row_ror:4 row_mask:0xf bank_mask:0xf
    v_max3_u32 v4, v4, v70, v71
    v_max3_u32 v5, v5, v72, v73
    v_max_f32_dpp v6, v6, v6 row_ror:8 row_mask:0xf bank_mask:0xf
    v_max_u32 v4, v4, v5
    v_cmp_eq_u32 vcc, -1, v4
    v_sub_f32 v6, v72, v6
    s_cmp_eq_u64 vcc, 0
    s_cbranch_scc1 L_CB_ok
    s_sub_u32 s71, s71, 1
    s_cmp_lt_i32 s71, 0
    s_cbranch_scc1 L_CB_ok
    s_sleep 1
    s_branch L_CB_poll
L_CB_ok:
    v_mul_f32 v6, 0x3fb8aa3b, v6
    v_exp_f32 v6, v6
    s_nop 0
    v_mul_f32 v72, v6, v73
    v_pk_mul_f32 v[64:65], v[64:65], v[6:7] op_sel_hi:[1,0]
    v_pk_mul_f32 v[66:67], v[66:67], v[6:7] op_sel_hi:[1,0]
    v_pk_mul_f32 v[68:69], v[68:69], v[6:7] op_sel_hi:[1,0]
    v_pk_mul_f32 v[70:71], v[70:71], v[6:7] op_sel_hi:[1,0]
    v_add_f32_dpp v72, v72, v72 row_ror:2 row_mask:0xf bank_mask:0xf
    v_add_f32_dpp v64, v64, v64 row_ror:2 row_mask:0xf bank_mask:0xf
    v_add_f32_dpp v65, v65, v65 row_ror:2 row_mask:0xf bank_mask:0xf
    v_add_f32_dpp v66, v66, v66 row_ror:2 row_mask:0xf bank_mask:0xf
    v_add_f32_dpp v67, v67, v67 row_ror:2 row_mask:0xf bank_mask:0xf
    v_add_f32_dpp v68, v68, v68 row_ror:2 row_mask:0xf bank_mask:0xf
    v_add_f32_dpp v69, v69, v69 row_ror:2 row_mask:0xf bank_mask:0xf
    v_add_f32_dpp v70, v70, v70 row_ror:2 row_mask:0xf bank_mask:0xf
    v_add_f32_dpp v71, v71, v71 row_ror:2 row_mask:0xf bank_mask:0xf
    v_add_f32_dpp v72, v72, v72 row_ror:4 row_mask:0xf bank_mask:0xf
    v_add_f32_dpp v64, v64, v64 row_ror:4 row_mask:0xf bank_mask:0xf
    v_add_f32_dpp v65, v65, v65 row_ror:4 row_mask:0xf bank_mask:0xf
    v_add_f32_dpp v66, v66, v66 row_ror:4 row_mask:0xf bank_mask:0xf
    v_add_f32_dpp v67, v67, v67 row_ror:4 row_mask:0xf bank_mask:0xf
    v_add_f32_dpp v68, v68, v68 row_ror:4 row_mask:0xf bank_mask:0xf
    v_add_f32_dpp v69, v69, v69 row_ror:4 row_mask:0xf bank_mask:0xf
    v_add_f32_dpp v70, v70, v70 row_ror:4 row_mask:0xf bank_mask:0xf
    v_add_f32_dpp v71, v71, v71 row_ror:4 row_mask:0xf bank_mask:0xf
    v_add_f32_dpp v72, v72, v72 row_ror:8 row_mask:0xf bank_mask:0xf
    v_add_f32_dpp v64, v64, v64 row_ror:8 row_mask:0xf bank_mask:0xf
    v_rcp_f32 v6, v72
    v_add_f32_dpp v65, v65, v65 row_ror:8 row_mask:0xf bank_mask:0xf
    v_add_f32_dpp v66, v66, v66 row_ror:8 row_mask:0xf bank_mask:0xf
    v_add_f32_dpp v67, v67, v67 row_ror:8 row_mask:0xf bank_mask:0xf
    v_add_f32_dpp v68, v68, v68 row_ror:8 row_mask:0xf bank_mask:0xf
    v_add_f32_dpp v69, v69, v69 row_ror:8 row_mask:0xf bank_mask:0xf
    v_add_f32_dpp v70, v70, v70 row_ror:8 row_mask:0xf bank_mask:0xf
    v_add_f32_dpp v71, v71, v71 row_ror:8 row_mask:0xf bank_mask:0xf
    v_pk_mul_f32 v[64:65], v[64:65], v[6:7] op_sel_hi:[1,0]
    v_pk_mul_f32 v[66:67], v[66:67], v[6:7] op_sel_hi:[1,0]
    v_pk_mul_f32 v[68:69], v[68:69], v[6:7] op_sel_hi:[1,0]
    v_pk_mul_f32 v[70:71], v[70:71], v[6:7] op_sel_hi:[1,0]
    v_cvt_pk_bf16_f32 v16, v64, v65
    v_cvt_pk_bf16_f32 v17, v66, v67
    v_cvt_pk_bf16_f32 v18, v68, v69
    v_cvt_pk_bf16_f32 v19, v70, v71
    s_nop 1
    v_mfma_f32_16x16x32_bf16 v[32:35], v[16:19], v[96:99], 0
    v_mfma_f32_16x16x32_bf16 v[48:51], v[16:19], v[112:115], 0
    v_mfma_f32_16x16x32_bf16 v[36:39], v[16:19], v[100:103], 0
    v_mfma_f32_16x16x32_bf16 v[52:55], v[16:19], v[116:119], 0
    v_mfma_f32_16x16x32_bf16 v[40:43], v[16:19], v[104:107], 0
    v_mfma_f32_16x16x32_bf16 v[56:59], v[16:19], v[120:123], 0
    v_mfma_f32_16x16x32_bf16 v[44:47], v[16:19], v[108:111], 0
    v_mfma_f32_16x16x32_bf16 v[60:63], v[16:19], v[124:127], 0
    s_nop 1
    v_add_f32_dpp v20, v33, v32 row_ror:8 row_mask:0xf bank_mask:0x3
    v_add_f32_dpp v20, v48, v49 row_ror:8 row_mask:0xf bank_mask:0xc
    v_add_f32_dpp v21, v37, v36 row_ror:8 row_mask:0xf bank_mask:0x3
    v_add_f32_dpp v21, v52, v53 row_ror:8 row_mask:0xf bank_mask:0xc
    v_add_f32_dpp v22, v41, v40 row_ror:8 row_mask:0xf bank_mask:0x3
    v_add_f32_dpp v22, v56, v57 row_ror:8 row_mask:0xf bank_mask:0xc
    v_add_f32_dpp v23, v45, v44 row_ror:8 row_mask:0xf bank_mask:0x3
    v_add_f32_dpp v23, v60, v61 row_ror:8 row_mask:0xf bank_mask:0xc
    s_mov_b64 exec, 0xffff
    ds_write_b128 v12, v[20:23] offset:2048
    s_mov_b64 exec, -1
    v_mov_b32 v2, s74
    v_mov_b32 v3, 1
    s_mov_b64 exec, 1
    ds_add_rtn_u32 v3, v2, v3
    s_mov_b64 exec, -1
    s_waitcnt lgkmcnt(0)
    v_readfirstlane_b32 s64, v3
    s_cmp_eq_u32 s64, 3
    s_cbranch_scc0 L_fin
    ds_read_b128 v[64:67], v8 offset:2048
    ds_read_b128 v[68:71], v8 offset:2304
    ds_read_b128 v[72:75], v8 offset:2560
    ds_read_b128 v[76:79], v8 offset:2816
    s_waitcnt lgkmcnt(2)
    v_pk_add_f32 v[64:65], v[64:65], v[68:69]
    v_pk_add_f32 v[66:67], v[66:67], v[70:71]
    s_waitcnt lgkmcnt(0)
    v_pk_add_f32 v[72:73], v[72:73], v[76:77]
    v_pk_add_f32 v[74:75], v[74:75], v[78:79]
    v_pk_add_f32 v[64:65], v[64:65], v[72:73]
    v_pk_add_f32 v[66:67], v[66:67], v[74:75]
    v_min_u32 v64, 0xfffffffe, v64
    v_min_u32 v65, 0xfffffffe, v65
    v_min_u32 v66, 0xfffffffe, v66
    v_min_u32 v67, 0xfffffffe, v67
    s_mov_b64 exec, 0xffff
    buffer_store_dwordx4 v[64:67], v11, s[48:51], s63 offen offset:0 sc1
    s_mov_b64 exec, -1
    s_branch L_fin
L_S:
    s_and_b32 s74, s5, 15
    s_lshr_b32 s75, s5, 4
    s_and_b32 s65, s5, 7
    s_lshl_b32 s65, s65, 1
    s_lshr_b32 s74, s74, 3
    s_add_u32 s74, s74, s65
    s_lshl_b32 s5, s74, 3
    s_add_u32 s5, s5, s75
    s_lshl_b32 s65, s74, 21
    s_lshl_b32 s66, s75, 16
    s_add_u32 s65, s65, s66
    s_lshl_b32 s66, s3, 13
    s_add_u32 s65, s65, s66
    s_add_u32 s65, s65, 1572864
    v_lshrrev_b32 v3, 4, v1
    v_and_b32 v2, 15, v1
    v_xor_b32 v6, v2, v3
    v_lshlrev_b32 v4, 4, v6
    v_lshl_add_u32 v4, v3, 8, v4
    v_add_u32 v16, s65, v4
    v_xor_b32 v17, 64, v16
    v_xor_b32 v18, 4224, v16
    v_xor_b32 v19, 4288, v16
    v_lshlrev_b32 v4, 11, v3
    v_lshl_add_u32 v2, v2, 4, v4
    v_add_u32 v10, s65, v2
    s_add_u32 s66, s66, 12288
    s_mov_b32 m0, s66
    v_bfe_u32 v4, v1, 2, 2
    v_lshlrev_b32 v4, 11, v4
    v_and_b32 v5, 3, v1
    v_lshl_add_u32 v4, v5, 8, v4
    v_lshl_add_u32 v4, v6, 4, v4
    v_add_u32 v24, s66, v4
    v_xor_b32 v25, 64, v24
    v_xor_b32 v26, 128, v24
    v_xor_b32 v27, 192, v24
    v_lshlrev_b32 v11, 4, v1
    v_and_b32 v2, 1, v1
    v_lshlrev_b32 v4, 8, v2
    v_lshl_add_u32 v8, v3, 4, v4
    v_lshlrev_b32 v12, 5, v2
    s_lshl_b32 s67, s3, 2
    v_add_u32 v13, s67, v12
    v_lshrrev_b32 v9, 5, v1
    v_lshlrev_b32 v9, 12, v9
    v_and_b32 v2, 31, v1
    v_lshl_add_u32 v9, v2, 4, v9
    s_lshl_b32 s60, s74, 4
    s_add_u32 s60, s60, s75
    s_lshl_b32 s60, s60, 9
    s_add_u32 s60, s60, 294912
    s_lshl_b32 s61, s5, 7
    s_add_u32 s61, s61, 425984
    s_waitcnt lgkmcnt(0)
    s_mov_b32 s48, s44
    s_mov_b32 s49, s45
    s_mov_b32 s50, 0x10000000
    s_mov_b32 s51, 0x00020000
    s_cmp_lt_u32 s3, 4
    s_cbranch_scc0 L_S_p1
    global_load_lds_dwordx4 v16, s[18:19] offset:0 nt
    global_load_lds_dwordx4 v16, s[18:19] offset:1024 nt
    global_load_lds_dwordx4 v17, s[18:19] offset:2048 nt
    global_load_lds_dwordx4 v17, s[18:19] offset:3072 nt
    s_add_u32 s66, s66, 4096
    s_mov_b32 m0, s66
    s_nop 0
    global_load_lds_dwordx4 v18, s[18:19] offset:0 nt
    global_load_lds_dwordx4 v18, s[18:19] offset:1024 nt
    global_load_lds_dwordx4 v19, s[18:19] offset:2048 nt
    global_load_lds_dwordx4 v19, s[18:19] offset:3072 nt
    s_cmp_eq_u32 s3, 0
    s_cbranch_scc0 L_S_w1
    v_mov_b32 v32, -1
    v_mov_b32 v33, -1
    v_mov_b32 v34, -1
    v_mov_b32 v35, -1
    buffer_store_dwordx4 v[32:35], v9, s[48:51], s60 offen sc1
    s_mov_b64 exec, 1
    buffer_store_dwordx4 v[32:35], v11, s[48:51], s61 offen offset:0 sc1
    s_mov_b64 exec, -1
    s_add_u32 s64, s60, 1048576
    buffer_store_dwordx4 v[32:35], v9, s[48:51], s64 offen sc1
    s_add_u32 s64, s61, 1048576
    s_mov_b64 exec, 1
    buffer_store_dwordx4 v[32:35], v11, s[48:51], s64 offen offset:0 sc1
    s_mov_b64 exec, -1
    s_waitcnt vmcnt(8)
    v_mov_b32 v2, 0
    global_load_dwordx2 v[14:15], v2, s[42:43] sc1
    s_waitcnt vmcnt(0)
L_S0_ep:
    v_readfirstlane_b32 s7, v15
    v_readfirstlane_b32 s6, v14
    s_cmp_lg_u32 s7, 0
    s_cbranch_scc1 L_S0_epok
    s_sub_u32 s71, s71, 1
    s_cmp_lt_i32 s71, 0
    s_cbranch_scc1 L_S0_epok
    s_sleep 1
    v_mov_b32 v2, 0
    global_load_dwordx2 v[14:15], v2, s[42:43] sc1
    s_waitcnt vmcnt(0)
    s_branch L_S0_ep
L_S0_epok:
    s_lshl_b32 s69, s5, 3
    s_add_u32 s69, s69, 508928
    s_mov_b64 exec, 1
    buffer_store_dwordx2 v[14:15], v11, s[48:51], s69 offen sc1
    s_mov_b64 exec, -1
    s_barrier
    s_branch L_S_b0
L_S_w1:
    s_waitcnt vmcnt(0)
    s_barrier
    s_branch L_S_b0
L_S_p1:
    s_barrier
    global_load_lds_dwordx4 v16, s[18:19] offset:0 nt
    global_load_lds_dwordx4 v16, s[18:19] offset:1024 nt
    global_load_lds_dwordx4 v17, s[18:19] offset:2048 nt
    global_load_lds_dwordx4 v17, s[18:19] offset:3072 nt
    s_add_u32 s66, s66, 4096
    s_mov_b32 m0, s66
    s_nop 0
    global_load_lds_dwordx4 v18, s[18:19] offset:0 nt
    global_load_lds_dwordx4 v18, s[18:19] offset:1024 nt
    global_load_lds_dwordx4 v19, s[18:19] offset:2048 nt
    global_load_lds_dwordx4 v19, s[18:19] offset:3072 nt
L_S_b0:
    s_barrier
    s_cmp_ge_u32 s3, 6
    s_cbranch_scc0 L_S_v
    s_waitcnt vmcnt(0)
    ds_read_b128 v[64:67], v24 offset:0
    ds_read_b128 v[68:71], v25 offset:0
    ds_read_b128 v[72:75], v26 offset:0
    ds_read_b128 v[76:79], v27 offset:0
    ds_read_b128 v[80:83], v24 offset:1024
    ds_read_b128 v[84:87], v25 offset:1024
    ds_read_b128 v[88:91], v26 offset:1024
    ds_read_b128 v[92:95], v27 offset:1024
    s_waitcnt lgkmcnt(0)
    s_barrier
    global_load_dwordx4 v[96:99], v10, s[20:21] offset:0 nt
    global_load_dwordx4 v[100:103], v10, s[20:21] offset:256 nt
    global_load_dwordx4 v[104:107], v10, s[20:21] offset:512 nt
    global_load_dwordx4 v[108:111], v10, s[20:21] offset:768 nt
    global_load_dwordx4 v[112:115], v10, s[20:21] offset:1024 nt
    global_load_dwordx4 v[116:119], v10, s[20:21] offset:1280 nt
    global_load_dwordx4 v[120:123], v10, s[20:21] offset:1536 nt
    global_load_dwordx4 v[124:127], v10, s[20:21] offset:1792 nt
    s_branch L_S_qk
L_S_v:
    global_load_dwordx4 v[96:99], v10, s[20:21] offset:0 nt
    global_load_dwordx4 v[100:103], v10, s[20:21] offset:256 nt
    global_load_dwordx4 v[104:107], v10, s[20:21] offset:512 nt
    global_load_dwordx4 v[108:111], v10, s[20:21] offset:768 nt
    global_load_dwordx4 v[112:115], v10, s[20:21] offset:1024 nt
    global_load_dwordx4 v[116:119], v10, s[20:21] offset:1280 nt
    global_load_dwordx4 v[120:123], v10, s[20:21] offset:1536 nt
    global_load_dwordx4 v[124:127], v10, s[20:21] offset:1792 nt
    s_cmp_eq_u32 s3, 0
    s_cbranch_scc0 L_S_b1
    s_lshl_b32 s65, s74, 12
    s_add_u32 s65, s65, 1179648
    s_mov_b32 s12, 3
    v_lshlrev_b32 v6, 2, v1
    s_waitcnt vmcnt(8)
    ds_read_b128 v[64:67], v24 offset:0
    ds_read_b128 v[68:71], v25 offset:0
    ds_read_b128 v[72:75], v26 offset:0
    ds_read_b128 v[76:79], v27 offset:0
    ds_read_b128 v[80:83], v24 offset:1024
    ds_read_b128 v[84:87], v25 offset:1024
    ds_read_b128 v[88:91], v26 offset:1024
    ds_read_b128 v[92:95], v27 offset:1024
    s_xor_b32 s67, s65, 1048576
L_S_poll:
    buffer_load_dwordx4 v[32:35], v11, s[48:51], s65 offen offset:0 sc1
    buffer_load_dwordx4 v[36:39], v11, s[48:51], s65 offen offset:1024 sc1
    buffer_load_dwordx4 v[40:43], v11, s[48:51], s65 offen offset:2048 sc1
    buffer_load_dwordx4 v[44:47], v11, s[48:51], s65 offen offset:3072 sc1
    s_cmp_lt_i32 s12, 0
    s_cbranch_scc1 L_S_poll2
    s_waitcnt vmcnt(0)
    v_xor_b32 v4, s6, v34
    v_xor_b32 v5, s7, v35
    v_bitop3_b32 v4, v4, v38, s6 bitop3:0xf6
    v_bitop3_b32 v5, v5, v39, s7 bitop3:0xf6
    v_bitop3_b32 v4, v4, v42, s6 bitop3:0xf6
    v_bitop3_b32 v5, v5, v43, s7 bitop3:0xf6
    v_bitop3_b32 v4, v4, v46, s6 bitop3:0xf6
    v_bitop3_b32 v5, v5, v47, s7 bitop3:0xf6
    v_or_b32 v4, v4, v5
    v_cmp_ne_u32 vcc, 0, v4
    s_cmp_eq_u64 vcc, 0
    s_cbranch_scc1 L_S_ok
    s_sub_u32 s12, s12, 1
    s_branch L_S_poll
L_S_poll2:
    buffer_load_dwordx4 v[48:51], v11, s[48:51], s67 offen offset:0 sc1
    buffer_load_dwordx4 v[52:55], v11, s[48:51], s67 offen offset:1024 sc1
    buffer_load_dwordx4 v[56:59], v11, s[48:51], s67 offen offset:2048 sc1
    buffer_load_dwordx4 v[60:63], v11, s[48:51], s67 offen offset:3072 sc1
    s_waitcnt vmcnt(0)
    v_xor_b32 v4, s6, v34
    v_xor_b32 v5, s7, v35
    v_bitop3_b32 v4, v4, v38, s6 bitop3:0xf6
    v_bitop3_b32 v5, v5, v39, s7 bitop3:0xf6
    v_bitop3_b32 v4, v4, v42, s6 bitop3:0xf6
    v_bitop3_b32 v5, v5, v43, s7 bitop3:0xf6
    v_bitop3_b32 v4, v4, v46, s6 bitop3:0xf6
    v_bitop3_b32 v5, v5, v47, s7 bitop3:0xf6
    v_or_b32 v4, v4, v5
    v_cmp_ne_u32 vcc, 0, v4
    s_cmp_eq_u64 vcc, 0
    s_cbranch_scc1 L_S_ok
    v_xor_b32 v4, s6, v50
    v_xor_b32 v5, s7, v51
    v_bitop3_b32 v4, v4, v54, s6 bitop3:0xf6
    v_bitop3_b32 v5, v5, v55, s7 bitop3:0xf6
    v_bitop3_b32 v4, v4, v58, s6 bitop3:0xf6
    v_bitop3_b32 v5, v5, v59, s7 bitop3:0xf6
    v_bitop3_b32 v4, v4, v62, s6 bitop3:0xf6
    v_bitop3_b32 v5, v5, v63, s7 bitop3:0xf6
    v_or_b32 v4, v4, v5
    v_cmp_ne_u32 vcc, 0, v4
    s_cmp_eq_u64 vcc, 0
    s_cbranch_scc1 L_S_ok2
    s_sub_u32 s71, s71, 1
    s_cmp_lt_i32 s71, 0
    s_cbranch_scc1 L_S_ok
    s_branch L_S_poll
L_S_ok2:
    v_mov_b32 v32, v48
    v_mov_b32 v33, v49
    v_mov_b32 v36, v52
    v_mov_b32 v37, v53
    v_mov_b32 v40, v56
    v_mov_b32 v41, v57
    v_mov_b32 v44, v60
    v_mov_b32 v45, v61
L_S_ok:
    v_pk_add_f32 v[32:33], v[32:33], v[40:41]
    v_pk_add_f32 v[36:37], v[36:37], v[44:45]
    v_cvt_pk_bf16_f32 v4, v32, v33
    v_cvt_pk_bf16_f32 v5, v36, v37
    ds_write2_b32 v6, v4, v5 offset0:0 offset1:64
    s_waitcnt lgkmcnt(0)
    s_barrier
    s_branch L_S_qk
L_S_b1:
    s_waitcnt vmcnt(8)
    ds_read_b128 v[64:67], v24 offset:0
    ds_read_b128 v[68:71], v25 offset:0
    ds_read_b128 v[72:75], v26 offset:0
    ds_read_b128 v[76:79], v27 offset:0
    ds_read_b128 v[80:83], v24 offset:1024
    ds_read_b128 v[84:87], v25 offset:1024
    ds_read_b128 v[88:91], v26 offset:1024
    ds_read_b128 v[92:95], v27 offset:1024
    s_waitcnt lgkmcnt(0)
    s_barrier
L_S_qk:
    ds_read_b128 v[16:19], v8 offset:0
    ds_read_b128 v[20:23], v8 offset:64
    ds_read_b128 v[24:27], v8 offset:128
    ds_read_b128 v[28:31], v8 offset:192
    s_waitcnt lgkmcnt(3)
    v_mfma_f32_16x16x32_bf16 v[32:35], v[64:67], v[16:19], 0
    v_mfma_f32_16x16x32_bf16 v[36:39], v[80:83], v[16:19], 0
    s_waitcnt lgkmcnt(2)
    v_mfma_f32_16x16x32_bf16 v[32:35], v[68:71], v[20:23], v[32:35]
    v_mfma_f32_16x16x32_bf16 v[36:39], v[84:87], v[20:23], v[36:39]
    s_waitcnt lgkmcnt(1)
    v_mfma_f32_16x16x32_bf16 v[32:35], v[72:75], v[24:27], v[32:35]
    v_mfma_f32_16x16x32_bf16 v[36:39], v[88:91], v[24:27], v[36:39]
    s_waitcnt lgkmcnt(0)
    v_mfma_f32_16x16x32_bf16 v[32:35], v[76:79], v[28:31], v[32:35]
    v_mfma_f32_16x16x32_bf16 v[36:39], v[92:95], v[28:31], v[36:39]
    s_mov_b32 s67, 0x3fb8aa3b
    s_mov_b32 s8, 0x3db504f3
    s_lshl_b32 s66, s3, 10
    s_add_u32 s66, s66, 2048
    v_lshl_add_u32 v10, v1, 5, s66
    s_nop 2
    v_cvt_pk_bf16_f32 v32, 0, v32
    v_cvt_pk_bf16_f32 v33, 0, v33
    v_cvt_pk_bf16_f32 v34, 0, v34
    v_cvt_pk_bf16_f32 v35, 0, v35
    v_cvt_pk_bf16_f32 v36, 0, v36
    v_cvt_pk_bf16_f32 v37, 0, v37
    v_cvt_pk_bf16_f32 v38, 0, v38
    v_cvt_pk_bf16_f32 v39, 0, v39
    v_pk_mul_f32 v[32:33], v[32:33], s[8:9] op_sel_hi:[1,0]
    v_pk_mul_f32 v[34:35], v[34:35], s[8:9] op_sel_hi:[1,0]
    v_pk_mul_f32 v[36:37], v[36:37], s[8:9] op_sel_hi:[1,0]
    v_pk_mul_f32 v[38:39], v[38:39], s[8:9] op_sel_hi:[1,0]
    v_cvt_pk_bf16_f32 v32, 0, v32
    v_cvt_pk_bf16_f32 v33, 0, v33
    v_cvt_pk_bf16_f32 v34, 0, v34
    v_cvt_pk_bf16_f32 v35, 0, v35
    v_cvt_pk_bf16_f32 v36, 0, v36
    v_cvt_pk_bf16_f32 v37, 0, v37
    v_cvt_pk_bf16_f32 v38, 0, v38
    v_cvt_pk_bf16_f32 v39, 0, v39
    v_max3_f32 v4, v32, v33, v34
    v_max3_f32 v5, v35, v36, v37
    v_max3_f32 v4, v4, v38, v39
    v_max_f32 v4, v4, v5
    v_mov_b32 v5, v4
    s_nop 1
    v_permlane16_swap_b32 v4, v5
    s_nop 0
    v_max_f32 v4, v4, v5
    v_mov_b32 v5, v4
    s_nop 1
    v_permlane32_swap_b32 v4, v5
    s_nop 0
    v_max_f32 v4, v4, v5
    ds_write_b32 v13, v4 offset:1536
    s_waitcnt lgkmcnt(0)
    s_barrier
    ds_read_b128 v[16:19], v12 offset:1536
    ds_read_b128 v[20:23], v12 offset:1552
    s_waitcnt lgkmcnt(0)
    v_max3_f32 v6, v16, v17, v18
    v_max3_f32 v5, v19, v20, v21
    v_max3_f32 v6, v6, v22, v23
    v_max_f32 v6, v6, v5
    v_mul_f32 v5, s67, v6
    v_fma_f32 v32, v32, s67, -v5
    v_fma_f32 v33, v33, s67, -v5
    v_fma_f32 v34, v34, s67, -v5
    v_fma_f32 v35, v35, s67, -v5
    v_fma_f32 v36, v36, s67, -v5
    v_fma_f32 v37, v37, s67, -v5
    v_fma_f32 v38, v38, s67, -v5
    v_fma_f32 v39, v39, s67, -v5
    v_exp_f32 v32, v32
    v_exp_f32 v33, v33
    v_exp_f32 v34, v34
    v_exp_f32 v35, v35
    v_exp_f32 v36, v36
    v_exp_f32 v37, v37
    v_exp_f32 v38, v38
    v_exp_f32 v39, v39
    v_add_f32 v16, v32, v33
    v_cvt_pk_bf16_f32 v24, v32, v33
    v_cvt_pk_bf16_f32 v25, v34, v35
    v_cvt_pk_bf16_f32 v26, v36, v37
    v_cvt_pk_bf16_f32 v27, v38, v39
    v_add_f32 v17, v34, v35
    v_add_f32 v18, v36, v37
    v_add_f32 v19, v38, v39
    s_waitcnt vmcnt(6)
    v_perm_b32 v64, v100, v96, s72
    v_perm_b32 v68, v100, v96, s73
    v_perm_b32 v72, v101, v97, s72
    v_perm_b32 v76, v101, v97, s73
    v_perm_b32 v80, v102, v98, s72
    v_perm_b32 v84, v102, v98, s73
    v_perm_b32 v88, v103, v99, s72
    v_perm_b32 v92, v103, v99, s73
    s_waitcnt vmcnt(4)
    v_perm_b32 v65, v108, v104, s72
    v_perm_b32 v69, v108, v104, s73
    v_perm_b32 v73, v109, v105, s72
    v_perm_b32 v77, v109, v105, s73
    v_perm_b32 v81, v110, v106, s72
    v_perm_b32 v85, v110, v106, s73
    v_perm_b32 v89, v111, v107, s72
    v_perm_b32 v93, v111, v107, s73
    s_waitcnt vmcnt(2)
    v_perm_b32 v66, v116, v112, s72
    v_perm_b32 v70, v116, v112, s73
    v_perm_b32 v74, v117, v113, s72
    v_perm_b32 v78, v117, v113, s73
    v_perm_b32 v82, v118, v114, s72
    v_perm_b32 v86, v118, v114, s73
    v_perm_b32 v90, v119, v115, s72
    v_perm_b32 v94, v119, v115, s73
    s_waitcnt vmcnt(0)
    v_perm_b32 v67, v124, v120, s72
    v_perm_b32 v71, v124, v120, s73
    v_perm_b32 v75, v125, v121, s72
    v_perm_b32 v79, v125, v121, s73
    v_perm_b32 v83, v126, v122, s72
    v_perm_b32 v87, v126, v122, s73
    v_perm_b32 v91, v127, v123, s72
    v_perm_b32 v95, v127, v123, s73
    s_nop 0
    v_mfma_f32_16x16x32_bf16 v[32:35], v[24:27], v[64:67], 0
    v_add_f32 v16, v16, v17
    v_add_f32 v18, v18, v19
    v_mfma_f32_16x16x32_bf16 v[36:39], v[24:27], v[68:71], 0
    v_add_f32 v4, v16, v18
    v_mfma_f32_16x16x32_bf16 v[40:43], v[24:27], v[72:75], 0
    v_mov_b32 v5, v4
    v_mfma_f32_16x16x32_bf16 v[44:47], v[24:27], v[76:79], 0
    v_mfma_f32_16x16x32_bf16 v[48:51], v[24:27], v[80:83], 0
    v_permlane16_swap_b32 v4, v5
    v_mfma_f32_16x16x32_bf16 v[52:55], v[24:27], v[84:87], 0
    v_add_f32 v4, v4, v5
    v_mfma_f32_16x16x32_bf16 v[56:59], v[24:27], v[88:91], 0
    v_mov_b32 v5, v4
    v_mfma_f32_16x16x32_bf16 v[60:63], v[24:27], v[92:95], 0
    s_mov_b64 exec, 0xffff
    ds_write2_b32 v10, v32, v33 offset0:0 offset1:128
    s_nop 0
    ds_write2_b32 v10, v36, v37 offset0:1 offset1:129
    ds_write2_b32 v10, v40, v41 offset0:2 offset1:130
    ds_write2_b32 v10, v44, v45 offset0:3 offset1:131
    ds_write2_b32 v10, v48, v49 offset0:4 offset1:132
    ds_write2_b32 v10, v52, v53 offset0:5 offset1:133
    ds_write2_b32 v10, v56, v57 offset0:6 offset1:134
    ds_write2_b32 v10, v60, v61 offset0:7 offset1:135
    s_mov_b64 exec, -1
    v_permlane32_swap_b32 v4, v5
    s_nop 0
    v_add_f32 v4, v4, v5
    ds_write_b32 v13, v4 offset:1600
    s_waitcnt lgkmcnt(0)
    s_barrier
    s_cmp_eq_u32 s3, 0
    s_cbranch_scc0 L_S_ml
    ds_read_b128 v[96:99], v11 offset:2048
    ds_read_b128 v[100:103], v11 offset:3072
    ds_read_b128 v[104:107], v11 offset:4096
    ds_read_b128 v[108:111], v11 offset:5120
    ds_read_b128 v[112:115], v11 offset:6144
    ds_read_b128 v[116:119], v11 offset:7168
    ds_read_b128 v[120:123], v11 offset:8192
    ds_read_b128 v[124:127], v11 offset:9216
    s_waitcnt lgkmcnt(4)
    v_pk_add_f32 v[96:97], v[96:97], v[100:101]
    v_pk_add_f32 v[98:99], v[98:99], v[102:103]
    v_pk_add_f32 v[104:105], v[104:105], v[108:109]
    v_pk_add_f32 v[106:107], v[106:107], v[110:111]
    v_pk_add_f32 v[96:97], v[96:97], v[104:105]
    v_pk_add_f32 v[98:99], v[98:99], v[106:107]
    s_waitcnt lgkmcnt(0)
    v_pk_add_f32 v[112:113], v[112:113], v[116:117]
    v_pk_add_f32 v[114:115], v[114:115], v[118:119]
    v_pk_add_f32 v[120:121], v[120:121], v[124:125]
    v_pk_add_f32 v[122:123], v[122:123], v[126:127]
    v_pk_add_f32 v[112:113], v[112:113], v[120:121]
    v_pk_add_f32 v[114:115], v[114:115], v[122:123]
    v_pk_add_f32 v[96:97], v[96:97], v[112:113]
    v_pk_add_f32 v[98:99], v[98:99], v[114:115]
    v_min_u32 v96, 0xfffffffe, v96
    v_min_u32 v97, 0xfffffffe, v97
    v_min_u32 v98, 0xfffffffe, v98
    v_min_u32 v99, 0xfffffffe, v99
    s_add_u32 s64, s60, 1048576
    buffer_store_dwordx4 v[96:99], v9, s[48:51], s64 offen
    buffer_store_dwordx4 v[96:99], v9, s[48:51], s60 offen sc1
    s_branch L_fin
L_S_ml:
    s_cmp_eq_u32 s3, 1
    s_cbranch_scc0 L_fin
    ds_read_b128 v[16:19], v12 offset:1600
    ds_read_b128 v[20:23], v12 offset:1616
    v_lshlrev_b32 v2, 3, v1
    v_min_u32 v6, 0xfffffffe, v6
    s_waitcnt lgkmcnt(0)
    v_pk_add_f32 v[16:17], v[16:17], v[20:21]
    v_pk_add_f32 v[18:19], v[18:19], v[22:23]
    v_pk_add_f32 v[16:17], v[16:17], v[18:19]
    v_add_f32 v7, v16, v17
    v_min_u32 v7, 0xfffffffe, v7
    s_mov_b64 exec, 3
    s_add_u32 s64, s61, 1048576
    buffer_store_dwordx2 v[6:7], v2, s[48:51], s64 offen
    buffer_store_dwordx2 v[6:7], v2, s[48:51], s61 offen sc1
    s_mov_b64 exec, -1
    s_branch L_fin
L_T:
    s_setprio 3
    s_sub_u32 s5, s2, 256
    s_mov_b32 s4, 0
    s_lshr_b32 s74, s5, 4
    s_lshl_b32 s74, s74, 3
    s_and_b32 s65, s5, 7
    s_or_b32 s74, s74, s65
    v_lshlrev_b32 v3, 4, v0
    v_lshlrev_b32 v4, 1, v0
    v_add_u32 v4, 8192, v4
    s_waitcnt lgkmcnt(0)
    global_load_dwordx4 v[96:99], v3, s[28:29]
    global_load_dwordx4 v[100:103], v3, s[30:31]
    global_load_dwordx4 v[36:39], v3, s[32:33]
    global_load_ushort v104, v4, s[28:29]
    global_load_ushort v105, v4, s[30:31]
    global_load_ushort v40, v4, s[32:33]
    s_setprio 0
    s_mov_b32 s48, s44
    s_mov_b32 s49, s45
    s_mov_b32 s50, 0x10000000
    s_mov_b32 s51, 0x00020000
    v_mov_b32 v124, 0xbdd2d3e8
    v_mov_b32 v126, 0xc0135761
    v_mov_b32 v125, 0xbdd2d3e8
    v_mov_b32 v127, 0xc0135761
    s_lshl_b32 s65, s74, 16
    s_or_b32 s65, s65, 0x3f800000
    s_mov_b32 s8, 0xba000000
    s_bitcmp1_b32 s5, 3
    s_cselect_b32 s8, 0x3a000000, s8
    v_mov_b32 v80, 0
    v_mov_b32 v81, 0
    v_mov_b32 v82, 0
    v_mov_b32 v83, 0
    v_mov_b32 v84, 0
    v_mov_b32 v85, 0
    v_mov_b32 v86, 0
    v_mov_b32 v87, 0
    v_mov_b32 v88, 0
    v_mov_b32 v89, 0
    v_mov_b32 v90, 0
    v_mov_b32 v91, 0
    v_mov_b32 v92, 0
    v_mov_b32 v93, 0
    v_mov_b32 v94, 0
    v_mov_b32 v95, 0
    s_waitcnt vmcnt(0)
    v_lshlrev_b32 v16, 16, v96
    v_and_b32 v17, 0xffff0000, v96
    v_lshlrev_b32 v26, 16, v100
    v_and_b32 v27, 0xffff0000, v100
    v_lshlrev_b32 v18, 16, v97
    v_and_b32 v19, 0xffff0000, v97
    v_lshlrev_b32 v28, 16, v101
    v_and_b32 v29, 0xffff0000, v101
    v_lshlrev_b32 v20, 16, v98
    v_and_b32 v21, 0xffff0000, v98
    v_lshlrev_b32 v30, 16, v102
    v_and_b32 v31, 0xffff0000, v102
    v_lshlrev_b32 v22, 16, v99
    v_and_b32 v23, 0xffff0000, v99
    v_lshlrev_b32 v32, 16, v103
    v_and_b32 v33, 0xffff0000, v103
    v_lshlrev_b32 v24, 16, v104
    v_lshlrev_b32 v34, 16, v105
    v_mul_f32 v42, s65, v16
    v_mul_f32 v43, s65, v17
    v_mul_f32 v44, s65, v18
    v_mul_f32 v45, s65, v19
    v_mul_f32 v46, s65, v20
    v_mul_f32 v47, s65, v21
    v_mul_f32 v48, s65, v22
    v_mul_f32 v49, s65, v23
    v_mul_f32 v50, s65, v24
    v_cvt_pk_bf16_f32 v42, 0, v42
    v_cvt_pk_bf16_f32 v43, 0, v43
    v_cvt_pk_bf16_f32 v44, 0, v44
    v_cvt_pk_bf16_f32 v45, 0, v45
    v_cvt_pk_bf16_f32 v46, 0, v46
    v_cvt_pk_bf16_f32 v47, 0, v47
    v_cvt_pk_bf16_f32 v48, 0, v48
    v_cvt_pk_bf16_f32 v49, 0, v49
    v_cvt_pk_bf16_f32 v50, 0, v50
    v_pk_fma_f32 v[52:53], v[42:43], s[8:9], v[26:27] op_sel_hi:[1,0,1]
    v_pk_fma_f32 v[54:55], v[44:45], s[8:9], v[28:29] op_sel_hi:[1,0,1]
    v_pk_fma_f32 v[56:57], v[46:47], s[8:9], v[30:31] op_sel_hi:[1,0,1]
    v_pk_fma_f32 v[58:59], v[48:49], s[8:9], v[32:33] op_sel_hi:[1,0,1]
    v_fma_f32 v60, v50, s8, v34
    v_cvt_pk_bf16_f32 v52, 0, v52
    v_cvt_pk_bf16_f32 v53, 0, v53
    v_cvt_pk_bf16_f32 v54, 0, v54
    v_cvt_pk_bf16_f32 v55, 0, v55
    v_cvt_pk_bf16_f32 v56, 0, v56
    v_cvt_pk_bf16_f32 v57, 0, v57
    v_cvt_pk_bf16_f32 v58, 0, v58
    v_cvt_pk_bf16_f32 v59, 0, v59
    v_cvt_pk_bf16_f32 v60, 0, v60
    v_pk_mul_f32 v[62:63], v[52:53], v[52:53]
    v_pk_mul_f32 v[64:65], v[54:55], v[54:55]
    v_pk_mul_f32 v[66:67], v[56:57], v[56:57]
    v_pk_mul_f32 v[68:69], v[58:59], v[58:59]
    v_mul_f32 v70, v60, v60
    v_pk_fma_f32 v[62:63], v[62:63], v[124:125], v[126:127]
    v_pk_fma_f32 v[64:65], v[64:65], v[124:125], v[126:127]
    v_pk_fma_f32 v[66:67], v[66:67], v[124:125], v[126:127]
    v_pk_fma_f32 v[68:69], v[68:69], v[124:125], v[126:127]
    v_fma_f32 v70, v70, v124, v126
    v_pk_mul_f32 v[62:63], v[62:63], v[52:53]
    v_pk_mul_f32 v[64:65], v[64:65], v[54:55]
    v_pk_mul_f32 v[66:67], v[66:67], v[56:57]
    v_pk_mul_f32 v[68:69], v[68:69], v[58:59]
    v_mul_f32 v70, v70, v60
    v_exp_f32 v62, v62
    v_exp_f32 v63, v63
    v_exp_f32 v64, v64
    v_exp_f32 v65, v65
    v_exp_f32 v66, v66
    v_exp_f32 v67, v67
    v_exp_f32 v68, v68
    v_exp_f32 v69, v69
    v_exp_f32 v70, v70
    v_pk_add_f32 v[62:63], v[62:63], 1.0 op_sel_hi:[1,0]
    v_pk_add_f32 v[64:65], v[64:65], 1.0 op_sel_hi:[1,0]
    v_pk_add_f32 v[66:67], v[66:67], 1.0 op_sel_hi:[1,0]
    v_pk_add_f32 v[68:69], v[68:69], 1.0 op_sel_hi:[1,0]
    v_add_f32 v70, 1.0, v70
    v_rcp_f32 v62, v62
    v_rcp_f32 v63, v63
    v_rcp_f32 v64, v64
    v_rcp_f32 v65, v65
    v_rcp_f32 v66, v66
    v_rcp_f32 v67, v67
    v_rcp_f32 v68, v68
    v_rcp_f32 v69, v69
    v_rcp_f32 v70, v70
    v_pk_mul_f32 v[62:63], v[62:63], v[52:53]
    v_pk_mul_f32 v[64:65], v[64:65], v[54:55]
    v_pk_mul_f32 v[66:67], v[66:67], v[56:57]
    v_pk_mul_f32 v[68:69], v[68:69], v[58:59]
    v_mul_f32 v70, v70, v60
    v_cvt_pk_bf16_f32 v72, v62, v63
    v_cvt_pk_bf16_f32 v73, v64, v65
    v_cvt_pk_bf16_f32 v74, v66, v67
    v_cvt_pk_bf16_f32 v75, v68, v69
    v_cvt_pk_bf16_f32 v76, v70, 0
    v_dot2c_f32_bf16 v80, v72, v36
    v_dot2c_f32_bf16 v80, v73, v37
    v_dot2c_f32_bf16 v80, v74, v38
    v_dot2c_f32_bf16 v80, v75, v39
    v_dot2c_f32_bf16 v80, v76, v40
    s_add_u32 s8, s8, 8388608
    v_pk_fma_f32 v[52:53], v[42:43], s[8:9], v[26:27] op_sel_hi:[1,0,1]
    v_pk_fma_f32 v[54:55], v[44:45], s[8:9], v[28:29] op_sel_hi:[1,0,1]
    v_pk_fma_f32 v[56:57], v[46:47], s[8:9], v[30:31] op_sel_hi:[1,0,1]
    v_pk_fma_f32 v[58:59], v[48:49], s[8:9], v[32:33] op_sel_hi:[1,0,1]
    v_fma_f32 v60, v50, s8, v34
    v_cvt_pk_bf16_f32 v52, 0, v52
    v_cvt_pk_bf16_f32 v53, 0, v53
    v_cvt_pk_bf16_f32 v54, 0, v54
    v_cvt_pk_bf16_f32 v55, 0, v55
    v_cvt_pk_bf16_f32 v56, 0, v56
    v_cvt_pk_bf16_f32 v57, 0, v57
    v_cvt_pk_bf16_f32 v58, 0, v58
    v_cvt_pk_bf16_f32 v59, 0, v59
    v_cvt_pk_bf16_f32 v60, 0, v60
    v_pk_mul_f32 v[62:63], v[52:53], v[52:53]
    v_pk_mul_f32 v[64:65], v[54:55], v[54:55]
    v_pk_mul_f32 v[66:67], v[56:57], v[56:57]
    v_pk_mul_f32 v[68:69], v[58:59], v[58:59]
    v_mul_f32 v70, v60, v60
    v_pk_fma_f32 v[62:63], v[62:63], v[124:125], v[126:127]
    v_pk_fma_f32 v[64:65], v[64:65], v[124:125], v[126:127]
    v_pk_fma_f32 v[66:67], v[66:67], v[124:125], v[126:127]
    v_pk_fma_f32 v[68:69], v[68:69], v[124:125], v[126:127]
    v_fma_f32 v70, v70, v124, v126
    v_pk_mul_f32 v[62:63], v[62:63], v[52:53]
    v_pk_mul_f32 v[64:65], v[64:65], v[54:55]
    v_pk_mul_f32 v[66:67], v[66:67], v[56:57]
    v_pk_mul_f32 v[68:69], v[68:69], v[58:59]
    v_mul_f32 v70, v70, v60
    v_exp_f32 v62, v62
    v_exp_f32 v63, v63
    v_exp_f32 v64, v64
    v_exp_f32 v65, v65
    v_exp_f32 v66, v66
    v_exp_f32 v67, v67
    v_exp_f32 v68, v68
    v_exp_f32 v69, v69
    v_exp_f32 v70, v70
    v_pk_add_f32 v[62:63], v[62:63], 1.0 op_sel_hi:[1,0]
    v_pk_add_f32 v[64:65], v[64:65], 1.0 op_sel_hi:[1,0]
    v_pk_add_f32 v[66:67], v[66:67], 1.0 op_sel_hi:[1,0]
    v_pk_add_f32 v[68:69], v[68:69], 1.0 op_sel_hi:[1,0]
    v_add_f32 v70, 1.0, v70
    v_rcp_f32 v62, v62
    v_rcp_f32 v63, v63
    v_rcp_f32 v64, v64
    v_rcp_f32 v65, v65
    v_rcp_f32 v66, v66
    v_rcp_f32 v67, v67
    v_rcp_f32 v68, v68
    v_rcp_f32 v69, v69
    v_rcp_f32 v70, v70
    v_pk_mul_f32 v[62:63], v[62:63], v[52:53]
    v_pk_mul_f32 v[64:65], v[64:65], v[54:55]
    v_pk_mul_f32 v[66:67], v[66:67], v[56:57]
    v_pk_mul_f32 v[68:69], v[68:69], v[58:59]
    v_mul_f32 v70, v70, v60
    v_cvt_pk_bf16_f32 v72, v62, v63
    v_cvt_pk_bf16_f32 v73, v64, v65
    v_cvt_pk_bf16_f32 v74, v66, v67
    v_cvt_pk_bf16_f32 v75, v68, v69
    v_cvt_pk_bf16_f32 v76, v70, 0
    v_dot2c_f32_bf16 v81, v72, v36
    v_dot2c_f32_bf16 v81, v73, v37
    v_dot2c_f32_bf16 v81, v74, v38
    v_dot2c_f32_bf16 v81, v75, v39
    v_dot2c_f32_bf16 v81, v76, v40
    s_add_u32 s8, s8, 8388608
    v_pk_fma_f32 v[52:53], v[42:43], s[8:9], v[26:27] op_sel_hi:[1,0,1]
    v_pk_fma_f32 v[54:55], v[44:45], s[8:9], v[28:29] op_sel_hi:[1,0,1]
    v_pk_fma_f32 v[56:57], v[46:47], s[8:9], v[30:31] op_sel_hi:[1,0,1]
    v_pk_fma_f32 v[58:59], v[48:49], s[8:9], v[32:33] op_sel_hi:[1,0,1]
    v_fma_f32 v60, v50, s8, v34
    v_cvt_pk_bf16_f32 v52, 0, v52
    v_cvt_pk_bf16_f32 v53, 0, v53
    v_cvt_pk_bf16_f32 v54, 0, v54
    v_cvt_pk_bf16_f32 v55, 0, v55
    v_cvt_pk_bf16_f32 v56, 0, v56
    v_cvt_pk_bf16_f32 v57, 0, v57
    v_cvt_pk_bf16_f32 v58, 0, v58
    v_cvt_pk_bf16_f32 v59, 0, v59
    v_cvt_pk_bf16_f32 v60, 0, v60
    v_pk_mul_f32 v[62:63], v[52:53], v[52:53]
    v_pk_mul_f32 v[64:65], v[54:55], v[54:55]
    v_pk_mul_f32 v[66:67], v[56:57], v[56:57]
    v_pk_mul_f32 v[68:69], v[58:59], v[58:59]
    v_mul_f32 v70, v60, v60
    v_pk_fma_f32 v[62:63], v[62:63], v[124:125], v[126:127]
    v_pk_fma_f32 v[64:65], v[64:65], v[124:125], v[126:127]
    v_pk_fma_f32 v[66:67], v[66:67], v[124:125], v[126:127]
    v_pk_fma_f32 v[68:69], v[68:69], v[124:125], v[126:127]
    v_fma_f32 v70, v70, v124, v126
    v_pk_mul_f32 v[62:63], v[62:63], v[52:53]
    v_pk_mul_f32 v[64:65], v[64:65], v[54:55]
    v_pk_mul_f32 v[66:67], v[66:67], v[56:57]
    v_pk_mul_f32 v[68:69], v[68:69], v[58:59]
    v_mul_f32 v70, v70, v60
    v_exp_f32 v62, v62
    v_exp_f32 v63, v63
    v_exp_f32 v64, v64
    v_exp_f32 v65, v65
    v_exp_f32 v66, v66
    v_exp_f32 v67, v67
    v_exp_f32 v68, v68
    v_exp_f32 v69, v69
    v_exp_f32 v70, v70
    v_pk_add_f32 v[62:63], v[62:63], 1.0 op_sel_hi:[1,0]
    v_pk_add_f32 v[64:65], v[64:65], 1.0 op_sel_hi:[1,0]
    v_pk_add_f32 v[66:67], v[66:67], 1.0 op_sel_hi:[1,0]
    v_pk_add_f32 v[68:69], v[68:69], 1.0 op_sel_hi:[1,0]
    v_add_f32 v70, 1.0, v70
    v_rcp_f32 v62, v62
    v_rcp_f32 v63, v63
    v_rcp_f32 v64, v64
    v_rcp_f32 v65, v65
    v_rcp_f32 v66, v66
    v_rcp_f32 v67, v67
    v_rcp_f32 v68, v68
    v_rcp_f32 v69, v69
    v_rcp_f32 v70, v70
    v_pk_mul_f32 v[62:63], v[62:63], v[52:53]
    v_pk_mul_f32 v[64:65], v[64:65], v[54:55]
    v_pk_mul_f32 v[66:67], v[66:67], v[56:57]
    v_pk_mul_f32 v[68:69], v[68:69], v[58:59]
    v_mul_f32 v70, v70, v60
    v_cvt_pk_bf16_f32 v72, v62, v63
    v_cvt_pk_bf16_f32 v73, v64, v65
    v_cvt_pk_bf16_f32 v74, v66, v67
    v_cvt_pk_bf16_f32 v75, v68, v69
    v_cvt_pk_bf16_f32 v76, v70, 0
    v_dot2c_f32_bf16 v82, v72, v36
    v_dot2c_f32_bf16 v82, v73, v37
    v_dot2c_f32_bf16 v82, v74, v38
    v_dot2c_f32_bf16 v82, v75, v39
    v_dot2c_f32_bf16 v82, v76, v40
    s_add_u32 s8, s8, 8388608
    v_pk_fma_f32 v[52:53], v[42:43], s[8:9], v[26:27] op_sel_hi:[1,0,1]
    v_pk_fma_f32 v[54:55], v[44:45], s[8:9], v[28:29] op_sel_hi:[1,0,1]
    v_pk_fma_f32 v[56:57], v[46:47], s[8:9], v[30:31] op_sel_hi:[1,0,1]
    v_pk_fma_f32 v[58:59], v[48:49], s[8:9], v[32:33] op_sel_hi:[1,0,1]
    v_fma_f32 v60, v50, s8, v34
    v_cvt_pk_bf16_f32 v52, 0, v52
    v_cvt_pk_bf16_f32 v53, 0, v53
    v_cvt_pk_bf16_f32 v54, 0, v54
    v_cvt_pk_bf16_f32 v55, 0, v55
    v_cvt_pk_bf16_f32 v56, 0, v56
    v_cvt_pk_bf16_f32 v57, 0, v57
    v_cvt_pk_bf16_f32 v58, 0, v58
    v_cvt_pk_bf16_f32 v59, 0, v59
    v_cvt_pk_bf16_f32 v60, 0, v60
    v_pk_mul_f32 v[62:63], v[52:53], v[52:53]
    v_pk_mul_f32 v[64:65], v[54:55], v[54:55]
    v_pk_mul_f32 v[66:67], v[56:57], v[56:57]
    v_pk_mul_f32 v[68:69], v[58:59], v[58:59]
    v_mul_f32 v70, v60, v60
    v_pk_fma_f32 v[62:63], v[62:63], v[124:125], v[126:127]
    v_pk_fma_f32 v[64:65], v[64:65], v[124:125], v[126:127]
    v_pk_fma_f32 v[66:67], v[66:67], v[124:125], v[126:127]
    v_pk_fma_f32 v[68:69], v[68:69], v[124:125], v[126:127]
    v_fma_f32 v70, v70, v124, v126
    v_pk_mul_f32 v[62:63], v[62:63], v[52:53]
    v_pk_mul_f32 v[64:65], v[64:65], v[54:55]
    v_pk_mul_f32 v[66:67], v[66:67], v[56:57]
    v_pk_mul_f32 v[68:69], v[68:69], v[58:59]
    v_mul_f32 v70, v70, v60
    v_exp_f32 v62, v62
    v_exp_f32 v63, v63
    v_exp_f32 v64, v64
    v_exp_f32 v65, v65
    v_exp_f32 v66, v66
    v_exp_f32 v67, v67
    v_exp_f32 v68, v68
    v_exp_f32 v69, v69
    v_exp_f32 v70, v70
    v_pk_add_f32 v[62:63], v[62:63], 1.0 op_sel_hi:[1,0]
    v_pk_add_f32 v[64:65], v[64:65], 1.0 op_sel_hi:[1,0]
    v_pk_add_f32 v[66:67], v[66:67], 1.0 op_sel_hi:[1,0]
    v_pk_add_f32 v[68:69], v[68:69], 1.0 op_sel_hi:[1,0]
    v_add_f32 v70, 1.0, v70
    v_rcp_f32 v62, v62
    v_rcp_f32 v63, v63
    v_rcp_f32 v64, v64
    v_rcp_f32 v65, v65
    v_rcp_f32 v66, v66
    v_rcp_f32 v67, v67
    v_rcp_f32 v68, v68
    v_rcp_f32 v69, v69
    v_rcp_f32 v70, v70
    v_pk_mul_f32 v[62:63], v[62:63], v[52:53]
    v_pk_mul_f32 v[64:65], v[64:65], v[54:55]
    v_pk_mul_f32 v[66:67], v[66:67], v[56:57]
    v_pk_mul_f32 v[68:69], v[68:69], v[58:59]
    v_mul_f32 v70, v70, v60
    v_cvt_pk_bf16_f32 v72, v62, v63
    v_cvt_pk_bf16_f32 v73, v64, v65
    v_cvt_pk_bf16_f32 v74, v66, v67
    v_cvt_pk_bf16_f32 v75, v68, v69
    v_cvt_pk_bf16_f32 v76, v70, 0
    v_dot2c_f32_bf16 v83, v72, v36
    v_dot2c_f32_bf16 v83, v73, v37
    v_dot2c_f32_bf16 v83, v74, v38
    v_dot2c_f32_bf16 v83, v75, v39
    v_dot2c_f32_bf16 v83, v76, v40
    s_add_u32 s8, s8, 8388608
    v_pk_fma_f32 v[52:53], v[42:43], s[8:9], v[26:27] op_sel_hi:[1,0,1]
    v_pk_fma_f32 v[54:55], v[44:45], s[8:9], v[28:29] op_sel_hi:[1,0,1]
    v_pk_fma_f32 v[56:57], v[46:47], s[8:9], v[30:31] op_sel_hi:[1,0,1]
    v_pk_fma_f32 v[58:59], v[48:49], s[8:9], v[32:33] op_sel_hi:[1,0,1]
    v_fma_f32 v60, v50, s8, v34
    v_cvt_pk_bf16_f32 v52, 0, v52
    v_cvt_pk_bf16_f32 v53, 0, v53
    v_cvt_pk_bf16_f32 v54, 0, v54
    v_cvt_pk_bf16_f32 v55, 0, v55
    v_cvt_pk_bf16_f32 v56, 0, v56
    v_cvt_pk_bf16_f32 v57, 0, v57
    v_cvt_pk_bf16_f32 v58, 0, v58
    v_cvt_pk_bf16_f32 v59, 0, v59
    v_cvt_pk_bf16_f32 v60, 0, v60
    v_pk_mul_f32 v[62:63], v[52:53], v[52:53]
    v_pk_mul_f32 v[64:65], v[54:55], v[54:55]
    v_pk_mul_f32 v[66:67], v[56:57], v[56:57]
    v_pk_mul_f32 v[68:69], v[58:59], v[58:59]
    v_mul_f32 v70, v60, v60
    v_pk_fma_f32 v[62:63], v[62:63], v[124:125], v[126:127]
    v_pk_fma_f32 v[64:65], v[64:65], v[124:125], v[126:127]
    v_pk_fma_f32 v[66:67], v[66:67], v[124:125], v[126:127]
    v_pk_fma_f32 v[68:69], v[68:69], v[124:125], v[126:127]
    v_fma_f32 v70, v70, v124, v126
    v_pk_mul_f32 v[62:63], v[62:63], v[52:53]
    v_pk_mul_f32 v[64:65], v[64:65], v[54:55]
    v_pk_mul_f32 v[66:67], v[66:67], v[56:57]
    v_pk_mul_f32 v[68:69], v[68:69], v[58:59]
    v_mul_f32 v70, v70, v60
    v_exp_f32 v62, v62
    v_exp_f32 v63, v63
    v_exp_f32 v64, v64
    v_exp_f32 v65, v65
    v_exp_f32 v66, v66
    v_exp_f32 v67, v67
    v_exp_f32 v68, v68
    v_exp_f32 v69, v69
    v_exp_f32 v70, v70
    v_pk_add_f32 v[62:63], v[62:63], 1.0 op_sel_hi:[1,0]
    v_pk_add_f32 v[64:65], v[64:65], 1.0 op_sel_hi:[1,0]
    v_pk_add_f32 v[66:67], v[66:67], 1.0 op_sel_hi:[1,0]
    v_pk_add_f32 v[68:69], v[68:69], 1.0 op_sel_hi:[1,0]
    v_add_f32 v70, 1.0, v70
    v_rcp_f32 v62, v62
    v_rcp_f32 v63, v63
    v_rcp_f32 v64, v64
    v_rcp_f32 v65, v65
    v_rcp_f32 v66, v66
    v_rcp_f32 v67, v67
    v_rcp_f32 v68, v68
    v_rcp_f32 v69, v69
    v_rcp_f32 v70, v70
    v_pk_mul_f32 v[62:63], v[62:63], v[52:53]
    v_pk_mul_f32 v[64:65], v[64:65], v[54:55]
    v_pk_mul_f32 v[66:67], v[66:67], v[56:57]
    v_pk_mul_f32 v[68:69], v[68:69], v[58:59]
    v_mul_f32 v70, v70, v60
    v_cvt_pk_bf16_f32 v72, v62, v63
    v_cvt_pk_bf16_f32 v73, v64, v65
    v_cvt_pk_bf16_f32 v74, v66, v67
    v_cvt_pk_bf16_f32 v75, v68, v69
    v_cvt_pk_bf16_f32 v76, v70, 0
    v_dot2c_f32_bf16 v84, v72, v36
    v_dot2c_f32_bf16 v84, v73, v37
    v_dot2c_f32_bf16 v84, v74, v38
    v_dot2c_f32_bf16 v84, v75, v39
    v_dot2c_f32_bf16 v84, v76, v40
    s_add_u32 s8, s8, 8388608
    v_pk_fma_f32 v[52:53], v[42:43], s[8:9], v[26:27] op_sel_hi:[1,0,1]
    v_pk_fma_f32 v[54:55], v[44:45], s[8:9], v[28:29] op_sel_hi:[1,0,1]
    v_pk_fma_f32 v[56:57], v[46:47], s[8:9], v[30:31] op_sel_hi:[1,0,1]
    v_pk_fma_f32 v[58:59], v[48:49], s[8:9], v[32:33] op_sel_hi:[1,0,1]
    v_fma_f32 v60, v50, s8, v34
    v_cvt_pk_bf16_f32 v52, 0, v52
    v_cvt_pk_bf16_f32 v53, 0, v53
    v_cvt_pk_bf16_f32 v54, 0, v54
    v_cvt_pk_bf16_f32 v55, 0, v55
    v_cvt_pk_bf16_f32 v56, 0, v56
    v_cvt_pk_bf16_f32 v57, 0, v57
    v_cvt_pk_bf16_f32 v58, 0, v58
    v_cvt_pk_bf16_f32 v59, 0, v59
    v_cvt_pk_bf16_f32 v60, 0, v60
    v_pk_mul_f32 v[62:63], v[52:53], v[52:53]
    v_pk_mul_f32 v[64:65], v[54:55], v[54:55]
    v_pk_mul_f32 v[66:67], v[56:57], v[56:57]
    v_pk_mul_f32 v[68:69], v[58:59], v[58:59]
    v_mul_f32 v70, v60, v60
    v_pk_fma_f32 v[62:63], v[62:63], v[124:125], v[126:127]
    v_pk_fma_f32 v[64:65], v[64:65], v[124:125], v[126:127]
    v_pk_fma_f32 v[66:67], v[66:67], v[124:125], v[126:127]
    v_pk_fma_f32 v[68:69], v[68:69], v[124:125], v[126:127]
    v_fma_f32 v70, v70, v124, v126
    v_pk_mul_f32 v[62:63], v[62:63], v[52:53]
    v_pk_mul_f32 v[64:65], v[64:65], v[54:55]
    v_pk_mul_f32 v[66:67], v[66:67], v[56:57]
    v_pk_mul_f32 v[68:69], v[68:69], v[58:59]
    v_mul_f32 v70, v70, v60
    v_exp_f32 v62, v62
    v_exp_f32 v63, v63
    v_exp_f32 v64, v64
    v_exp_f32 v65, v65
    v_exp_f32 v66, v66
    v_exp_f32 v67, v67
    v_exp_f32 v68, v68
    v_exp_f32 v69, v69
    v_exp_f32 v70, v70
    v_pk_add_f32 v[62:63], v[62:63], 1.0 op_sel_hi:[1,0]
    v_pk_add_f32 v[64:65], v[64:65], 1.0 op_sel_hi:[1,0]
    v_pk_add_f32 v[66:67], v[66:67], 1.0 op_sel_hi:[1,0]
    v_pk_add_f32 v[68:69], v[68:69], 1.0 op_sel_hi:[1,0]
    v_add_f32 v70, 1.0, v70
    v_rcp_f32 v62, v62
    v_rcp_f32 v63, v63
    v_rcp_f32 v64, v64
    v_rcp_f32 v65, v65
    v_rcp_f32 v66, v66
    v_rcp_f32 v67, v67
    v_rcp_f32 v68, v68
    v_rcp_f32 v69, v69
    v_rcp_f32 v70, v70
    v_pk_mul_f32 v[62:63], v[62:63], v[52:53]
    v_pk_mul_f32 v[64:65], v[64:65], v[54:55]
    v_pk_mul_f32 v[66:67], v[66:67], v[56:57]
    v_pk_mul_f32 v[68:69], v[68:69], v[58:59]
    v_mul_f32 v70, v70, v60
    v_cvt_pk_bf16_f32 v72, v62, v63
    v_cvt_pk_bf16_f32 v73, v64, v65
    v_cvt_pk_bf16_f32 v74, v66, v67
    v_cvt_pk_bf16_f32 v75, v68, v69
    v_cvt_pk_bf16_f32 v76, v70, 0
    v_dot2c_f32_bf16 v85, v72, v36
    v_dot2c_f32_bf16 v85, v73, v37
    v_dot2c_f32_bf16 v85, v74, v38
    v_dot2c_f32_bf16 v85, v75, v39
    v_dot2c_f32_bf16 v85, v76, v40
    s_add_u32 s8, s8, 8388608
    v_pk_fma_f32 v[52:53], v[42:43], s[8:9], v[26:27] op_sel_hi:[1,0,1]
    v_pk_fma_f32 v[54:55], v[44:45], s[8:9], v[28:29] op_sel_hi:[1,0,1]
    v_pk_fma_f32 v[56:57], v[46:47], s[8:9], v[30:31] op_sel_hi:[1,0,1]
    v_pk_fma_f32 v[58:59], v[48:49], s[8:9], v[32:33] op_sel_hi:[1,0,1]
    v_fma_f32 v60, v50, s8, v34
    v_cvt_pk_bf16_f32 v52, 0, v52
    v_cvt_pk_bf16_f32 v53, 0, v53
    v_cvt_pk_bf16_f32 v54, 0, v54
    v_cvt_pk_bf16_f32 v55, 0, v55
    v_cvt_pk_bf16_f32 v56, 0, v56
    v_cvt_pk_bf16_f32 v57, 0, v57
    v_cvt_pk_bf16_f32 v58, 0, v58
    v_cvt_pk_bf16_f32 v59, 0, v59
    v_cvt_pk_bf16_f32 v60, 0, v60
    v_pk_mul_f32 v[62:63], v[52:53], v[52:53]
    v_pk_mul_f32 v[64:65], v[54:55], v[54:55]
    v_pk_mul_f32 v[66:67], v[56:57], v[56:57]
    v_pk_mul_f32 v[68:69], v[58:59], v[58:59]
    v_mul_f32 v70, v60, v60
    v_pk_fma_f32 v[62:63], v[62:63], v[124:125], v[126:127]
    v_pk_fma_f32 v[64:65], v[64:65], v[124:125], v[126:127]
    v_pk_fma_f32 v[66:67], v[66:67], v[124:125], v[126:127]
    v_pk_fma_f32 v[68:69], v[68:69], v[124:125], v[126:127]
    v_fma_f32 v70, v70, v124, v126
    v_pk_mul_f32 v[62:63], v[62:63], v[52:53]
    v_pk_mul_f32 v[64:65], v[64:65], v[54:55]
    v_pk_mul_f32 v[66:67], v[66:67], v[56:57]
    v_pk_mul_f32 v[68:69], v[68:69], v[58:59]
    v_mul_f32 v70, v70, v60
    v_exp_f32 v62, v62
    v_exp_f32 v63, v63
    v_exp_f32 v64, v64
    v_exp_f32 v65, v65
    v_exp_f32 v66, v66
    v_exp_f32 v67, v67
    v_exp_f32 v68, v68
    v_exp_f32 v69, v69
    v_exp_f32 v70, v70
    v_pk_add_f32 v[62:63], v[62:63], 1.0 op_sel_hi:[1,0]
    v_pk_add_f32 v[64:65], v[64:65], 1.0 op_sel_hi:[1,0]
    v_pk_add_f32 v[66:67], v[66:67], 1.0 op_sel_hi:[1,0]
    v_pk_add_f32 v[68:69], v[68:69], 1.0 op_sel_hi:[1,0]
    v_add_f32 v70, 1.0, v70
    v_rcp_f32 v62, v62
    v_rcp_f32 v63, v63
    v_rcp_f32 v64, v64
    v_rcp_f32 v65, v65
    v_rcp_f32 v66, v66
    v_rcp_f32 v67, v67
    v_rcp_f32 v68, v68
    v_rcp_f32 v69, v69
    v_rcp_f32 v70, v70
    v_pk_mul_f32 v[62:63], v[62:63], v[52:53]
    v_pk_mul_f32 v[64:65], v[64:65], v[54:55]
    v_pk_mul_f32 v[66:67], v[66:67], v[56:57]
    v_pk_mul_f32 v[68:69], v[68:69], v[58:59]
    v_mul_f32 v70, v70, v60
    v_cvt_pk_bf16_f32 v72, v62, v63
    v_cvt_pk_bf16_f32 v73, v64, v65
    v_cvt_pk_bf16_f32 v74, v66, v67
    v_cvt_pk_bf16_f32 v75, v68, v69
    v_cvt_pk_bf16_f32 v76, v70, 0
    v_dot2c_f32_bf16 v86, v72, v36
    v_dot2c_f32_bf16 v86, v73, v37
    v_dot2c_f32_bf16 v86, v74, v38
    v_dot2c_f32_bf16 v86, v75, v39
    v_dot2c_f32_bf16 v86, v76, v40
    s_add_u32 s8, s8, 8388608
    v_pk_fma_f32 v[52:53], v[42:43], s[8:9], v[26:27] op_sel_hi:[1,0,1]
    v_pk_fma_f32 v[54:55], v[44:45], s[8:9], v[28:29] op_sel_hi:[1,0,1]
    v_pk_fma_f32 v[56:57], v[46:47], s[8:9], v[30:31] op_sel_hi:[1,0,1]
    v_pk_fma_f32 v[58:59], v[48:49], s[8:9], v[32:33] op_sel_hi:[1,0,1]
    v_fma_f32 v60, v50, s8, v34
    v_cvt_pk_bf16_f32 v52, 0, v52
    v_cvt_pk_bf16_f32 v53, 0, v53
    v_cvt_pk_bf16_f32 v54, 0, v54
    v_cvt_pk_bf16_f32 v55, 0, v55
    v_cvt_pk_bf16_f32 v56, 0, v56
    v_cvt_pk_bf16_f32 v57, 0, v57
    v_cvt_pk_bf16_f32 v58, 0, v58
    v_cvt_pk_bf16_f32 v59, 0, v59
    v_cvt_pk_bf16_f32 v60, 0, v60
    v_pk_mul_f32 v[62:63], v[52:53], v[52:53]
    v_pk_mul_f32 v[64:65], v[54:55], v[54:55]
    v_pk_mul_f32 v[66:67], v[56:57], v[56:57]
    v_pk_mul_f32 v[68:69], v[58:59], v[58:59]
    v_mul_f32 v70, v60, v60
    v_pk_fma_f32 v[62:63], v[62:63], v[124:125], v[126:127]
    v_pk_fma_f32 v[64:65], v[64:65], v[124:125], v[126:127]
    v_pk_fma_f32 v[66:67], v[66:67], v[124:125], v[126:127]
    v_pk_fma_f32 v[68:69], v[68:69], v[124:125], v[126:127]
    v_fma_f32 v70, v70, v124, v126
    v_pk_mul_f32 v[62:63], v[62:63], v[52:53]
    v_pk_mul_f32 v[64:65], v[64:65], v[54:55]
    v_pk_mul_f32 v[66:67], v[66:67], v[56:57]
    v_pk_mul_f32 v[68:69], v[68:69], v[58:59]
    v_mul_f32 v70, v70, v60
    v_exp_f32 v62, v62
    v_exp_f32 v63, v63
    v_exp_f32 v64, v64
    v_exp_f32 v65, v65
    v_exp_f32 v66, v66
    v_exp_f32 v67, v67
    v_exp_f32 v68, v68
    v_exp_f32 v69, v69
    v_exp_f32 v70, v70
    v_pk_add_f32 v[62:63], v[62:63], 1.0 op_sel_hi:[1,0]
    v_pk_add_f32 v[64:65], v[64:65], 1.0 op_sel_hi:[1,0]
    v_pk_add_f32 v[66:67], v[66:67], 1.0 op_sel_hi:[1,0]
    v_pk_add_f32 v[68:69], v[68:69], 1.0 op_sel_hi:[1,0]
    v_add_f32 v70, 1.0, v70
    v_rcp_f32 v62, v62
    v_rcp_f32 v63, v63
    v_rcp_f32 v64, v64
    v_rcp_f32 v65, v65
    v_rcp_f32 v66, v66
    v_rcp_f32 v67, v67
    v_rcp_f32 v68, v68
    v_rcp_f32 v69, v69
    v_rcp_f32 v70, v70
    v_pk_mul_f32 v[62:63], v[62:63], v[52:53]
    v_pk_mul_f32 v[64:65], v[64:65], v[54:55]
    v_pk_mul_f32 v[66:67], v[66:67], v[56:57]
    v_pk_mul_f32 v[68:69], v[68:69], v[58:59]
    v_mul_f32 v70, v70, v60
    v_cvt_pk_bf16_f32 v72, v62, v63
    v_cvt_pk_bf16_f32 v73, v64, v65
    v_cvt_pk_bf16_f32 v74, v66, v67
    v_cvt_pk_bf16_f32 v75, v68, v69
    v_cvt_pk_bf16_f32 v76, v70, 0
    v_dot2c_f32_bf16 v87, v72, v36
    v_dot2c_f32_bf16 v87, v73, v37
    v_dot2c_f32_bf16 v87, v74, v38
    v_dot2c_f32_bf16 v87, v75, v39
    v_dot2c_f32_bf16 v87, v76, v40
    s_add_u32 s8, s8, 8388608
    v_pk_fma_f32 v[52:53], v[42:43], s[8:9], v[26:27] op_sel_hi:[1,0,1]
    v_pk_fma_f32 v[54:55], v[44:45], s[8:9], v[28:29] op_sel_hi:[1,0,1]
    v_pk_fma_f32 v[56:57], v[46:47], s[8:9], v[30:31] op_sel_hi:[1,0,1]
    v_pk_fma_f32 v[58:59], v[48:49], s[8:9], v[32:33] op_sel_hi:[1,0,1]
    v_fma_f32 v60, v50, s8, v34
    v_cvt_pk_bf16_f32 v52, 0, v52
    v_cvt_pk_bf16_f32 v53, 0, v53
    v_cvt_pk_bf16_f32 v54, 0, v54
    v_cvt_pk_bf16_f32 v55, 0, v55
    v_cvt_pk_bf16_f32 v56, 0, v56
    v_cvt_pk_bf16_f32 v57, 0, v57
    v_cvt_pk_bf16_f32 v58, 0, v58
    v_cvt_pk_bf16_f32 v59, 0, v59
    v_cvt_pk_bf16_f32 v60, 0, v60
    v_pk_mul_f32 v[62:63], v[52:53], v[52:53]
    v_pk_mul_f32 v[64:65], v[54:55], v[54:55]
    v_pk_mul_f32 v[66:67], v[56:57], v[56:57]
    v_pk_mul_f32 v[68:69], v[58:59], v[58:59]
    v_mul_f32 v70, v60, v60
    v_pk_fma_f32 v[62:63], v[62:63], v[124:125], v[126:127]
    v_pk_fma_f32 v[64:65], v[64:65], v[124:125], v[126:127]
    v_pk_fma_f32 v[66:67], v[66:67], v[124:125], v[126:127]
    v_pk_fma_f32 v[68:69], v[68:69], v[124:125], v[126:127]
    v_fma_f32 v70, v70, v124, v126
    v_pk_mul_f32 v[62:63], v[62:63], v[52:53]
    v_pk_mul_f32 v[64:65], v[64:65], v[54:55]
    v_pk_mul_f32 v[66:67], v[66:67], v[56:57]
    v_pk_mul_f32 v[68:69], v[68:69], v[58:59]
    v_mul_f32 v70, v70, v60
    v_exp_f32 v62, v62
    v_exp_f32 v63, v63
    v_exp_f32 v64, v64
    v_exp_f32 v65, v65
    v_exp_f32 v66, v66
    v_exp_f32 v67, v67
    v_exp_f32 v68, v68
    v_exp_f32 v69, v69
    v_exp_f32 v70, v70
    v_pk_add_f32 v[62:63], v[62:63], 1.0 op_sel_hi:[1,0]
    v_pk_add_f32 v[64:65], v[64:65], 1.0 op_sel_hi:[1,0]
    v_pk_add_f32 v[66:67], v[66:67], 1.0 op_sel_hi:[1,0]
    v_pk_add_f32 v[68:69], v[68:69], 1.0 op_sel_hi:[1,0]
    v_add_f32 v70, 1.0, v70
    v_rcp_f32 v62, v62
    v_rcp_f32 v63, v63
    v_rcp_f32 v64, v64
    v_rcp_f32 v65, v65
    v_rcp_f32 v66, v66
    v_rcp_f32 v67, v67
    v_rcp_f32 v68, v68
    v_rcp_f32 v69, v69
    v_rcp_f32 v70, v70
    v_pk_mul_f32 v[62:63], v[62:63], v[52:53]
    v_pk_mul_f32 v[64:65], v[64:65], v[54:55]
    v_pk_mul_f32 v[66:67], v[66:67], v[56:57]
    v_pk_mul_f32 v[68:69], v[68:69], v[58:59]
    v_mul_f32 v70, v70, v60
    v_cvt_pk_bf16_f32 v72, v62, v63
    v_cvt_pk_bf16_f32 v73, v64, v65
    v_cvt_pk_bf16_f32 v74, v66, v67
    v_cvt_pk_bf16_f32 v75, v68, v69
    v_cvt_pk_bf16_f32 v76, v70, 0
    v_dot2c_f32_bf16 v88, v72, v36
    v_dot2c_f32_bf16 v88, v73, v37
    v_dot2c_f32_bf16 v88, v74, v38
    v_dot2c_f32_bf16 v88, v75, v39
    v_dot2c_f32_bf16 v88, v76, v40
    s_add_u32 s8, s8, 8388608
    v_pk_fma_f32 v[52:53], v[42:43], s[8:9], v[26:27] op_sel_hi:[1,0,1]
    v_pk_fma_f32 v[54:55], v[44:45], s[8:9], v[28:29] op_sel_hi:[1,0,1]
    v_pk_fma_f32 v[56:57], v[46:47], s[8:9], v[30:31] op_sel_hi:[1,0,1]
    v_pk_fma_f32 v[58:59], v[48:49], s[8:9], v[32:33] op_sel_hi:[1,0,1]
    v_fma_f32 v60, v50, s8, v34
    v_cvt_pk_bf16_f32 v52, 0, v52
    v_cvt_pk_bf16_f32 v53, 0, v53
    v_cvt_pk_bf16_f32 v54, 0, v54
    v_cvt_pk_bf16_f32 v55, 0, v55
    v_cvt_pk_bf16_f32 v56, 0, v56
    v_cvt_pk_bf16_f32 v57, 0, v57
    v_cvt_pk_bf16_f32 v58, 0, v58
    v_cvt_pk_bf16_f32 v59, 0, v59
    v_cvt_pk_bf16_f32 v60, 0, v60
    v_pk_mul_f32 v[62:63], v[52:53], v[52:53]
    v_pk_mul_f32 v[64:65], v[54:55], v[54:55]
    v_pk_mul_f32 v[66:67], v[56:57], v[56:57]
    v_pk_mul_f32 v[68:69], v[58:59], v[58:59]
    v_mul_f32 v70, v60, v60
    v_pk_fma_f32 v[62:63], v[62:63], v[124:125], v[126:127]
    v_pk_fma_f32 v[64:65], v[64:65], v[124:125], v[126:127]
    v_pk_fma_f32 v[66:67], v[66:67], v[124:125], v[126:127]
    v_pk_fma_f32 v[68:69], v[68:69], v[124:125], v[126:127]
    v_fma_f32 v70, v70, v124, v126
    v_pk_mul_f32 v[62:63], v[62:63], v[52:53]
    v_pk_mul_f32 v[64:65], v[64:65], v[54:55]
    v_pk_mul_f32 v[66:67], v[66:67], v[56:57]
    v_pk_mul_f32 v[68:69], v[68:69], v[58:59]
    v_mul_f32 v70, v70, v60
    v_exp_f32 v62, v62
    v_exp_f32 v63, v63
    v_exp_f32 v64, v64
    v_exp_f32 v65, v65
    v_exp_f32 v66, v66
    v_exp_f32 v67, v67
    v_exp_f32 v68, v68
    v_exp_f32 v69, v69
    v_exp_f32 v70, v70
    v_pk_add_f32 v[62:63], v[62:63], 1.0 op_sel_hi:[1,0]
    v_pk_add_f32 v[64:65], v[64:65], 1.0 op_sel_hi:[1,0]
    v_pk_add_f32 v[66:67], v[66:67], 1.0 op_sel_hi:[1,0]
    v_pk_add_f32 v[68:69], v[68:69], 1.0 op_sel_hi:[1,0]
    v_add_f32 v70, 1.0, v70
    v_rcp_f32 v62, v62
    v_rcp_f32 v63, v63
    v_rcp_f32 v64, v64
    v_rcp_f32 v65, v65
    v_rcp_f32 v66, v66
    v_rcp_f32 v67, v67
    v_rcp_f32 v68, v68
    v_rcp_f32 v69, v69
    v_rcp_f32 v70, v70
    v_pk_mul_f32 v[62:63], v[62:63], v[52:53]
    v_pk_mul_f32 v[64:65], v[64:65], v[54:55]
    v_pk_mul_f32 v[66:67], v[66:67], v[56:57]
    v_pk_mul_f32 v[68:69], v[68:69], v[58:59]
    v_mul_f32 v70, v70, v60
    v_cvt_pk_bf16_f32 v72, v62, v63
    v_cvt_pk_bf16_f32 v73, v64, v65
    v_cvt_pk_bf16_f32 v74, v66, v67
    v_cvt_pk_bf16_f32 v75, v68, v69
    v_cvt_pk_bf16_f32 v76, v70, 0
    v_dot2c_f32_bf16 v89, v72, v36
    v_dot2c_f32_bf16 v89, v73, v37
    v_dot2c_f32_bf16 v89, v74, v38
    v_dot2c_f32_bf16 v89, v75, v39
    v_dot2c_f32_bf16 v89, v76, v40
    s_add_u32 s8, s8, 8388608
    v_pk_fma_f32 v[52:53], v[42:43], s[8:9], v[26:27] op_sel_hi:[1,0,1]
    v_pk_fma_f32 v[54:55], v[44:45], s[8:9], v[28:29] op_sel_hi:[1,0,1]
    v_pk_fma_f32 v[56:57], v[46:47], s[8:9], v[30:31] op_sel_hi:[1,0,1]
    v_pk_fma_f32 v[58:59], v[48:49], s[8:9], v[32:33] op_sel_hi:[1,0,1]
    v_fma_f32 v60, v50, s8, v34
    v_cvt_pk_bf16_f32 v52, 0, v52
    v_cvt_pk_bf16_f32 v53, 0, v53
    v_cvt_pk_bf16_f32 v54, 0, v54
    v_cvt_pk_bf16_f32 v55, 0, v55
    v_cvt_pk_bf16_f32 v56, 0, v56
    v_cvt_pk_bf16_f32 v57, 0, v57
    v_cvt_pk_bf16_f32 v58, 0, v58
    v_cvt_pk_bf16_f32 v59, 0, v59
    v_cvt_pk_bf16_f32 v60, 0, v60
    v_pk_mul_f32 v[62:63], v[52:53], v[52:53]
    v_pk_mul_f32 v[64:65], v[54:55], v[54:55]
    v_pk_mul_f32 v[66:67], v[56:57], v[56:57]
    v_pk_mul_f32 v[68:69], v[58:59], v[58:59]
    v_mul_f32 v70, v60, v60
    v_pk_fma_f32 v[62:63], v[62:63], v[124:125], v[126:127]
    v_pk_fma_f32 v[64:65], v[64:65], v[124:125], v[126:127]
    v_pk_fma_f32 v[66:67], v[66:67], v[124:125], v[126:127]
    v_pk_fma_f32 v[68:69], v[68:69], v[124:125], v[126:127]
    v_fma_f32 v70, v70, v124, v126
    v_pk_mul_f32 v[62:63], v[62:63], v[52:53]
    v_pk_mul_f32 v[64:65], v[64:65], v[54:55]
    v_pk_mul_f32 v[66:67], v[66:67], v[56:57]
    v_pk_mul_f32 v[68:69], v[68:69], v[58:59]
    v_mul_f32 v70, v70, v60
    v_exp_f32 v62, v62
    v_exp_f32 v63, v63
    v_exp_f32 v64, v64
    v_exp_f32 v65, v65
    v_exp_f32 v66, v66
    v_exp_f32 v67, v67
    v_exp_f32 v68, v68
    v_exp_f32 v69, v69
    v_exp_f32 v70, v70
    v_pk_add_f32 v[62:63], v[62:63], 1.0 op_sel_hi:[1,0]
    v_pk_add_f32 v[64:65], v[64:65], 1.0 op_sel_hi:[1,0]
    v_pk_add_f32 v[66:67], v[66:67], 1.0 op_sel_hi:[1,0]
    v_pk_add_f32 v[68:69], v[68:69], 1.0 op_sel_hi:[1,0]
    v_add_f32 v70, 1.0, v70
    v_rcp_f32 v62, v62
    v_rcp_f32 v63, v63
    v_rcp_f32 v64, v64
    v_rcp_f32 v65, v65
    v_rcp_f32 v66, v66
    v_rcp_f32 v67, v67
    v_rcp_f32 v68, v68
    v_rcp_f32 v69, v69
    v_rcp_f32 v70, v70
    v_pk_mul_f32 v[62:63], v[62:63], v[52:53]
    v_pk_mul_f32 v[64:65], v[64:65], v[54:55]
    v_pk_mul_f32 v[66:67], v[66:67], v[56:57]
    v_pk_mul_f32 v[68:69], v[68:69], v[58:59]
    v_mul_f32 v70, v70, v60
    v_cvt_pk_bf16_f32 v72, v62, v63
    v_cvt_pk_bf16_f32 v73, v64, v65
    v_cvt_pk_bf16_f32 v74, v66, v67
    v_cvt_pk_bf16_f32 v75, v68, v69
    v_cvt_pk_bf16_f32 v76, v70, 0
    v_dot2c_f32_bf16 v90, v72, v36
    v_dot2c_f32_bf16 v90, v73, v37
    v_dot2c_f32_bf16 v90, v74, v38
    v_dot2c_f32_bf16 v90, v75, v39
    v_dot2c_f32_bf16 v90, v76, v40
    s_add_u32 s8, s8, 8388608
    v_pk_fma_f32 v[52:53], v[42:43], s[8:9], v[26:27] op_sel_hi:[1,0,1]
    v_pk_fma_f32 v[54:55], v[44:45], s[8:9], v[28:29] op_sel_hi:[1,0,1]
    v_pk_fma_f32 v[56:57], v[46:47], s[8:9], v[30:31] op_sel_hi:[1,0,1]
    v_pk_fma_f32 v[58:59], v[48:49], s[8:9], v[32:33] op_sel_hi:[1,0,1]
    v_fma_f32 v60, v50, s8, v34
    v_cvt_pk_bf16_f32 v52, 0, v52
    v_cvt_pk_bf16_f32 v53, 0, v53
    v_cvt_pk_bf16_f32 v54, 0, v54
    v_cvt_pk_bf16_f32 v55, 0, v55
    v_cvt_pk_bf16_f32 v56, 0, v56
    v_cvt_pk_bf16_f32 v57, 0, v57
    v_cvt_pk_bf16_f32 v58, 0, v58
    v_cvt_pk_bf16_f32 v59, 0, v59
    v_cvt_pk_bf16_f32 v60, 0, v60
    v_pk_mul_f32 v[62:63], v[52:53], v[52:53]
    v_pk_mul_f32 v[64:65], v[54:55], v[54:55]
    v_pk_mul_f32 v[66:67], v[56:57], v[56:57]
    v_pk_mul_f32 v[68:69], v[58:59], v[58:59]
    v_mul_f32 v70, v60, v60
    v_pk_fma_f32 v[62:63], v[62:63], v[124:125], v[126:127]
    v_pk_fma_f32 v[64:65], v[64:65], v[124:125], v[126:127]
    v_pk_fma_f32 v[66:67], v[66:67], v[124:125], v[126:127]
    v_pk_fma_f32 v[68:69], v[68:69], v[124:125], v[126:127]
    v_fma_f32 v70, v70, v124, v126
    v_pk_mul_f32 v[62:63], v[62:63], v[52:53]
    v_pk_mul_f32 v[64:65], v[64:65], v[54:55]
    v_pk_mul_f32 v[66:67], v[66:67], v[56:57]
    v_pk_mul_f32 v[68:69], v[68:69], v[58:59]
    v_mul_f32 v70, v70, v60
    v_exp_f32 v62, v62
    v_exp_f32 v63, v63
    v_exp_f32 v64, v64
    v_exp_f32 v65, v65
    v_exp_f32 v66, v66
    v_exp_f32 v67, v67
    v_exp_f32 v68, v68
    v_exp_f32 v69, v69
    v_exp_f32 v70, v70
    v_pk_add_f32 v[62:63], v[62:63], 1.0 op_sel_hi:[1,0]
    v_pk_add_f32 v[64:65], v[64:65], 1.0 op_sel_hi:[1,0]
    v_pk_add_f32 v[66:67], v[66:67], 1.0 op_sel_hi:[1,0]
    v_pk_add_f32 v[68:69], v[68:69], 1.0 op_sel_hi:[1,0]
    v_add_f32 v70, 1.0, v70
    v_rcp_f32 v62, v62
    v_rcp_f32 v63, v63
    v_rcp_f32 v64, v64
    v_rcp_f32 v65, v65
    v_rcp_f32 v66, v66
    v_rcp_f32 v67, v67
    v_rcp_f32 v68, v68
    v_rcp_f32 v69, v69
    v_rcp_f32 v70, v70
    v_pk_mul_f32 v[62:63], v[62:63], v[52:53]
    v_pk_mul_f32 v[64:65], v[64:65], v[54:55]
    v_pk_mul_f32 v[66:67], v[66:67], v[56:57]
    v_pk_mul_f32 v[68:69], v[68:69], v[58:59]
    v_mul_f32 v70, v70, v60
    v_cvt_pk_bf16_f32 v72, v62, v63
    v_cvt_pk_bf16_f32 v73, v64, v65
    v_cvt_pk_bf16_f32 v74, v66, v67
    v_cvt_pk_bf16_f32 v75, v68, v69
    v_cvt_pk_bf16_f32 v76, v70, 0
    v_dot2c_f32_bf16 v91, v72, v36
    v_dot2c_f32_bf16 v91, v73, v37
    v_dot2c_f32_bf16 v91, v74, v38
    v_dot2c_f32_bf16 v91, v75, v39
    v_dot2c_f32_bf16 v91, v76, v40
    s_add_u32 s8, s8, 8388608
    v_mov_b32 v2, 0
    global_load_dwordx2 v[96:97], v2, s[42:43] sc1
    v_pk_fma_f32 v[52:53], v[42:43], s[8:9], v[26:27] op_sel_hi:[1,0,1]
    v_pk_fma_f32 v[54:55], v[44:45], s[8:9], v[28:29] op_sel_hi:[1,0,1]
    v_pk_fma_f32 v[56:57], v[46:47], s[8:9], v[30:31] op_sel_hi:[1,0,1]
    v_pk_fma_f32 v[58:59], v[48:49], s[8:9], v[32:33] op_sel_hi:[1,0,1]
    v_fma_f32 v60, v50, s8, v34
    v_cvt_pk_bf16_f32 v52, 0, v52
    v_cvt_pk_bf16_f32 v53, 0, v53
    v_cvt_pk_bf16_f32 v54, 0, v54
    v_cvt_pk_bf16_f32 v55, 0, v55
    v_cvt_pk_bf16_f32 v56, 0, v56
    v_cvt_pk_bf16_f32 v57, 0, v57
    v_cvt_pk_bf16_f32 v58, 0, v58
    v_cvt_pk_bf16_f32 v59, 0, v59
    v_cvt_pk_bf16_f32 v60, 0, v60
    v_pk_mul_f32 v[62:63], v[52:53], v[52:53]
    v_pk_mul_f32 v[64:65], v[54:55], v[54:55]
    v_pk_mul_f32 v[66:67], v[56:57], v[56:57]
    v_pk_mul_f32 v[68:69], v[58:59], v[58:59]
    v_mul_f32 v70, v60, v60
    v_pk_fma_f32 v[62:63], v[62:63], v[124:125], v[126:127]
    v_pk_fma_f32 v[64:65], v[64:65], v[124:125], v[126:127]
    v_pk_fma_f32 v[66:67], v[66:67], v[124:125], v[126:127]
    v_pk_fma_f32 v[68:69], v[68:69], v[124:125], v[126:127]
    v_fma_f32 v70, v70, v124, v126
    v_pk_mul_f32 v[62:63], v[62:63], v[52:53]
    v_pk_mul_f32 v[64:65], v[64:65], v[54:55]
    v_pk_mul_f32 v[66:67], v[66:67], v[56:57]
    v_pk_mul_f32 v[68:69], v[68:69], v[58:59]
    v_mul_f32 v70, v70, v60
    v_exp_f32 v62, v62
    v_exp_f32 v63, v63
    v_exp_f32 v64, v64
    v_exp_f32 v65, v65
    v_exp_f32 v66, v66
    v_exp_f32 v67, v67
    v_exp_f32 v68, v68
    v_exp_f32 v69, v69
    v_exp_f32 v70, v70
    v_pk_add_f32 v[62:63], v[62:63], 1.0 op_sel_hi:[1,0]
    v_pk_add_f32 v[64:65], v[64:65], 1.0 op_sel_hi:[1,0]
    v_pk_add_f32 v[66:67], v[66:67], 1.0 op_sel_hi:[1,0]
    v_pk_add_f32 v[68:69], v[68:69], 1.0 op_sel_hi:[1,0]
    v_add_f32 v70, 1.0, v70
    v_rcp_f32 v62, v62
    v_rcp_f32 v63, v63
    v_rcp_f32 v64, v64
    v_rcp_f32 v65, v65
    v_rcp_f32 v66, v66
    v_rcp_f32 v67, v67
    v_rcp_f32 v68, v68
    v_rcp_f32 v69, v69
    v_rcp_f32 v70, v70
    v_pk_mul_f32 v[62:63], v[62:63], v[52:53]
    v_pk_mul_f32 v[64:65], v[64:65], v[54:55]
    v_pk_mul_f32 v[66:67], v[66:67], v[56:57]
    v_pk_mul_f32 v[68:69], v[68:69], v[58:59]
    v_mul_f32 v70, v70, v60
    v_cvt_pk_bf16_f32 v72, v62, v63
    v_cvt_pk_bf16_f32 v73, v64, v65
    v_cvt_pk_bf16_f32 v74, v66, v67
    v_cvt_pk_bf16_f32 v75, v68, v69
    v_cvt_pk_bf16_f32 v76, v70, 0
    v_dot2c_f32_bf16 v92, v72, v36
    v_dot2c_f32_bf16 v92, v73, v37
    v_dot2c_f32_bf16 v92, v74, v38
    v_dot2c_f32_bf16 v92, v75, v39
    v_dot2c_f32_bf16 v92, v76, v40
    s_add_u32 s8, s8, 8388608
    v_pk_fma_f32 v[52:53], v[42:43], s[8:9], v[26:27] op_sel_hi:[1,0,1]
    v_pk_fma_f32 v[54:55], v[44:45], s[8:9], v[28:29] op_sel_hi:[1,0,1]
    v_pk_fma_f32 v[56:57], v[46:47], s[8:9], v[30:31] op_sel_hi:[1,0,1]
    v_pk_fma_f32 v[58:59], v[48:49], s[8:9], v[32:33] op_sel_hi:[1,0,1]
    v_fma_f32 v60, v50, s8, v34
    v_cvt_pk_bf16_f32 v52, 0, v52
    v_cvt_pk_bf16_f32 v53, 0, v53
    v_cvt_pk_bf16_f32 v54, 0, v54
    v_cvt_pk_bf16_f32 v55, 0, v55
    v_cvt_pk_bf16_f32 v56, 0, v56
    v_cvt_pk_bf16_f32 v57, 0, v57
    v_cvt_pk_bf16_f32 v58, 0, v58
    v_cvt_pk_bf16_f32 v59, 0, v59
    v_cvt_pk_bf16_f32 v60, 0, v60
    v_pk_mul_f32 v[62:63], v[52:53], v[52:53]
    v_pk_mul_f32 v[64:65], v[54:55], v[54:55]
    v_pk_mul_f32 v[66:67], v[56:57], v[56:57]
    v_pk_mul_f32 v[68:69], v[58:59], v[58:59]
    v_mul_f32 v70, v60, v60
    v_pk_fma_f32 v[62:63], v[62:63], v[124:125], v[126:127]
    v_pk_fma_f32 v[64:65], v[64:65], v[124:125], v[126:127]
    v_pk_fma_f32 v[66:67], v[66:67], v[124:125], v[126:127]
    v_pk_fma_f32 v[68:69], v[68:69], v[124:125], v[126:127]
    v_fma_f32 v70, v70, v124, v126
    v_pk_mul_f32 v[62:63], v[62:63], v[52:53]
    v_pk_mul_f32 v[64:65], v[64:65], v[54:55]
    v_pk_mul_f32 v[66:67], v[66:67], v[56:57]
    v_pk_mul_f32 v[68:69], v[68:69], v[58:59]
    v_mul_f32 v70, v70, v60
    v_exp_f32 v62, v62
    v_exp_f32 v63, v63
    v_exp_f32 v64, v64
    v_exp_f32 v65, v65
    v_exp_f32 v66, v66
    v_exp_f32 v67, v67
    v_exp_f32 v68, v68
    v_exp_f32 v69, v69
    v_exp_f32 v70, v70
    v_pk_add_f32 v[62:63], v[62:63], 1.0 op_sel_hi:[1,0]
    v_pk_add_f32 v[64:65], v[64:65], 1.0 op_sel_hi:[1,0]
    v_pk_add_f32 v[66:67], v[66:67], 1.0 op_sel_hi:[1,0]
    v_pk_add_f32 v[68:69], v[68:69], 1.0 op_sel_hi:[1,0]
    v_add_f32 v70, 1.0, v70
    v_rcp_f32 v62, v62
    v_rcp_f32 v63, v63
    v_rcp_f32 v64, v64
    v_rcp_f32 v65, v65
    v_rcp_f32 v66, v66
    v_rcp_f32 v67, v67
    v_rcp_f32 v68, v68
    v_rcp_f32 v69, v69
    v_rcp_f32 v70, v70
    v_pk_mul_f32 v[62:63], v[62:63], v[52:53]
    v_pk_mul_f32 v[64:65], v[64:65], v[54:55]
    v_pk_mul_f32 v[66:67], v[66:67], v[56:57]
    v_pk_mul_f32 v[68:69], v[68:69], v[58:59]
    v_mul_f32 v70, v70, v60
    v_cvt_pk_bf16_f32 v72, v62, v63
    v_cvt_pk_bf16_f32 v73, v64, v65
    v_cvt_pk_bf16_f32 v74, v66, v67
    v_cvt_pk_bf16_f32 v75, v68, v69
    v_cvt_pk_bf16_f32 v76, v70, 0
    v_dot2c_f32_bf16 v93, v72, v36
    v_dot2c_f32_bf16 v93, v73, v37
    v_dot2c_f32_bf16 v93, v74, v38
    v_dot2c_f32_bf16 v93, v75, v39
    v_dot2c_f32_bf16 v93, v76, v40
    s_mov_b32 s8, 0xba000000
L_T_rows:
    s_nop 2
    v_add_f32_dpp v52, v80, v80 row_ror:8 row_mask:0xf bank_mask:0x3
    v_add_f32_dpp v52, v81, v81 row_ror:8 row_mask:0xf bank_mask:0xc
    v_add_f32_dpp v53, v82, v82 row_ror:8 row_mask:0xf bank_mask:0x3
    v_add_f32_dpp v53, v83, v83 row_ror:8 row_mask:0xf bank_mask:0xc
    v_add_f32_dpp v54, v84, v84 row_ror:8 row_mask:0xf bank_mask:0x3
    v_add_f32_dpp v54, v85, v85 row_ror:8 row_mask:0xf bank_mask:0xc
    v_add_f32_dpp v55, v86, v86 row_ror:8 row_mask:0xf bank_mask:0x3
    v_add_f32_dpp v55, v87, v87 row_ror:8 row_mask:0xf bank_mask:0xc
    v_add_f32_dpp v56, v88, v88 row_ror:8 row_mask:0xf bank_mask:0x3
    v_add_f32_dpp v56, v89, v89 row_ror:8 row_mask:0xf bank_mask:0xc
    v_add_f32_dpp v57, v90, v90 row_ror:8 row_mask:0xf bank_mask:0x3
    v_add_f32_dpp v57, v91, v91 row_ror:8 row_mask:0xf bank_mask:0xc
    v_add_f32_dpp v58, v92, v92 row_ror:8 row_mask:0xf bank_mask:0x3
    v_add_f32_dpp v58, v93, v93 row_ror:8 row_mask:0xf bank_mask:0xc
    v_add_f32_dpp v59, v94, v94 row_ror:8 row_mask:0xf bank_mask:0x3
    v_add_f32_dpp v59, v95, v95 row_ror:8 row_mask:0xf bank_mask:0xc
    v_add_f32_dpp v62, v52, v52 row_half_mirror row_mask:0xf bank_mask:0x5
    v_add_f32_dpp v62, v53, v53 row_half_mirror row_mask:0xf bank_mask:0xa
    v_add_f32_dpp v63, v54, v54 row_half_mirror row_mask:0xf bank_mask:0x5
    v_add_f32_dpp v63, v55, v55 row_half_mirror row_mask:0xf bank_mask:0xa
    v_add_f32_dpp v64, v56, v56 row_half_mirror row_mask:0xf bank_mask:0x5
    v_add_f32_dpp v64, v57, v57 row_half_mirror row_mask:0xf bank_mask:0xa
    v_add_f32_dpp v65, v58, v58 row_half_mirror row_mask:0xf bank_mask:0x5
    v_add_f32_dpp v65, v59, v59 row_half_mirror row_mask:0xf bank_mask:0xa
    v_add_f32_dpp v62, v62, v62 quad_perm:[1,0,3,2] row_mask:0xf bank_mask:0xf
    v_add_f32_dpp v63, v63, v63 quad_perm:[1,0,3,2] row_mask:0xf bank_mask:0xf
    v_add_f32_dpp v64, v64, v64 quad_perm:[1,0,3,2] row_mask:0xf bank_mask:0xf
    v_add_f32_dpp v65, v65, v65 quad_perm:[1,0,3,2] row_mask:0xf bank_mask:0xf
    v_add_f32_dpp v62, v62, v62 quad_perm:[2,3,0,1] row_mask:0xf bank_mask:0xf
    v_add_f32_dpp v63, v63, v63 quad_perm:[2,3,0,1] row_mask:0xf bank_mask:0xf
    v_add_f32_dpp v64, v64, v64 quad_perm:[2,3,0,1] row_mask:0xf bank_mask:0xf
    v_add_f32_dpp v65, v65, v65 quad_perm:[2,3,0,1] row_mask:0xf bank_mask:0xf
    s_nop 0
    v_permlane16_swap_b32 v62, v63
    v_permlane16_swap_b32 v64, v65
    s_nop 0
    v_add_f32 v62, v62, v63
    v_add_f32 v64, v64, v65
    s_nop 1
    v_permlane32_swap_b32 v62, v64
    v_bfe_u32 v2, v1, 3, 1
    v_bfe_u32 v3, v1, 2, 1
    v_lshl_add_u32 v2, v3, 1, v2
    v_lshrrev_b32 v3, 4, v1
    v_lshl_add_u32 v2, v3, 2, v2
    s_lshl_b32 s66, s3, 6
    v_lshl_add_u32 v2, v2, 2, s66
    v_add_f32 v62, v62, v64
    ds_write_b32 v2, v62 offset:0
    s_waitcnt vmcnt(0) lgkmcnt(0)
L_T_ep:
    v_readfirstlane_b32 s7, v97
    v_readfirstlane_b32 s6, v96
    s_cmp_lg_u32 s7, 0
    s_cbranch_scc1 L_T_epok
    s_sub_u32 s71, s71, 1
    s_cmp_lt_i32 s71, 0
    s_cbranch_scc1 L_T_epok
    v_mov_b32 v2, 0
    global_load_dwordx2 v[96:97], v2, s[42:43] sc1
    s_waitcnt vmcnt(0)
    s_branch L_T_ep
L_T_epok:
    s_barrier
    s_cmp_eq_u32 s3, 7
    s_cbranch_scc0 L_T_pubdone
    v_and_b32 v2, 7, v1
    v_lshlrev_b32 v3, 3, v2
    v_lshlrev_b32 v2, 4, v2
    ds_read_b64 v[96:97], v3 offset:0
    ds_read_b64 v[98:99], v3 offset:64
    ds_read_b64 v[100:101], v3 offset:128
    ds_read_b64 v[102:103], v3 offset:192
    ds_read_b64 v[104:105], v3 offset:256
    ds_read_b64 v[106:107], v3 offset:320
    ds_read_b64 v[108:109], v3 offset:384
    ds_read_b64 v[110:111], v3 offset:448
    s_lshl_b32 s65, s74, 8
    s_bitcmp1_b32 s5, 3
    s_cselect_b32 s66, 0, 128
    s_add_u32 s65, s65, s66
    s_add_u32 s65, s65, 524288
    s_waitcnt lgkmcnt(0)
    v_pk_add_f32 v[96:97], v[96:97], v[98:99]
    v_pk_add_f32 v[100:101], v[100:101], v[102:103]
    v_pk_add_f32 v[104:105], v[104:105], v[106:107]
    v_pk_add_f32 v[108:109], v[108:109], v[110:111]
    v_pk_add_f32 v[96:97], v[96:97], v[100:101]
    v_pk_add_f32 v[104:105], v[104:105], v[108:109]
    v_pk_add_f32 v[96:97], v[96:97], v[104:105]
    v_mov_b32 v98, s6
    v_mov_b32 v99, s7
    s_mov_b64 exec, 0xff
    buffer_store_dwordx4 v[96:99], v2, s[48:51], s65 offen offset:0 sc1
    s_mov_b64 exec, -1
L_T_pubdone:
    s_branch L_fin
L_E0:
    v_mov_b32 v2, 0
    global_load_dwordx2 v[14:15], v2, s[42:43] sc1
    s_waitcnt vmcnt(0)
L_E0_ep:
    v_readfirstlane_b32 s7, v15
    v_readfirstlane_b32 s6, v14
    s_cmp_lg_u32 s7, 0
    s_cbranch_scc1 L_E0_epok
    s_sub_u32 s71, s71, 1
    s_cmp_lt_i32 s71, 0
    s_cbranch_scc1 L_E0_epok
    s_sleep 2
    v_mov_b32 v2, 0
    global_load_dwordx2 v[14:15], v2, s[42:43] sc1
    s_waitcnt vmcnt(0)
    s_branch L_E0_ep
L_E0_epok:
L_E0b:
    v_lshlrev_b32 v3, 4, v0
    v_lshlrev_b32 v4, 1, v0
    v_add_u32 v4, 8192, v4
    global_load_dwordx4 v[96:99], v3, s[28:29]
    global_load_dwordx4 v[100:103], v3, s[30:31]
    global_load_dwordx4 v[36:39], v3, s[32:33]
    global_load_ushort v104, v4, s[28:29]
    global_load_ushort v105, v4, s[30:31]
    global_load_ushort v40, v4, s[32:33]
    v_mov_b32 v2, 0
    global_load_ushort v8, v2, s[34:35]
    v_mov_b32 v124, 0xbdd2d3e8
    v_mov_b32 v126, 0xc0135761
    v_mov_b32 v125, 0xbdd2d3e8
    v_mov_b32 v127, 0xc0135761
    s_waitcnt vmcnt(0)
    v_lshlrev_b32 v16, 16, v96
    v_and_b32 v17, 0xffff0000, v96
    v_lshlrev_b32 v26, 16, v100
    v_and_b32 v27, 0xffff0000, v100
    v_lshlrev_b32 v18, 16, v97
    v_and_b32 v19, 0xffff0000, v97
    v_lshlrev_b32 v28, 16, v101
    v_and_b32 v29, 0xffff0000, v101
    v_lshlrev_b32 v20, 16, v98
    v_and_b32 v21, 0xffff0000, v98
    v_lshlrev_b32 v30, 16, v102
    v_and_b32 v31, 0xffff0000, v102
    v_lshlrev_b32 v22, 16, v99
    v_and_b32 v23, 0xffff0000, v99
    v_lshlrev_b32 v32, 16, v103
    v_and_b32 v33, 0xffff0000, v103
    v_lshlrev_b32 v24, 16, v104
    v_lshlrev_b32 v34, 16, v105
    v_lshlrev_b32 v8, 16, v8
    s_cmp_ge_u32 s3, 5
    s_cbranch_scc1 L_E_tb
L_E:
    v_min_u32 v7, 287, v0
    v_lshlrev_b32 v9, 3, v7
    v_lshlrev_b32 v2, 2, v7
    global_load_dword v10, v2, s[16:17]
    v_mov_b32 v2, 0
    global_load_ushort v12, v2, s[16:17]
    v_lshlrev_b32 v11, 4, v1
    s_lshl_b32 s66, s3, 5
    v_lshrrev_b32 v2, 4, v1
    v_lshl_add_u32 v13, v2, 3, s66
    v_mov_b32 v4, -1
    v_mov_b32 v5, -1
    ds_write_b64 v13, v[4:5] offset:33280
    ds_write_b64 v13, v[4:5] offset:33456
    s_waitcnt lgkmcnt(0)
    s_barrier
    s_mov_b32 s68, 507904
L_E_fl:
    buffer_load_dwordx4 v[80:83], v11, s[48:51], s68 offen sc1
    s_waitcnt vmcnt(0)
    v_cmp_ne_u64 vcc, s[6:7], v[80:81]
    v_cmp_ne_u64 s[62:63], s[6:7], v[82:83]
    s_bitset0_b32 s63, 31
    s_or_b64 vcc, vcc, s[62:63]
    s_cmp_eq_u64 vcc, 0
    s_cbranch_scc1 L_E_pollM
    s_sub_u32 s71, s71, 1
    s_cmp_lt_i32 s71, 0
    s_cbranch_scc1 L_E_pollM
    s_sleep 8
    s_branch L_E_fl
L_E_pollM:
    s_mov_b32 s64, 479232
    buffer_load_dwordx2 v[52:53], v9, s[48:51], s64 offen sc1
    s_mov_b32 s64, 481536
    buffer_load_dwordx2 v[54:55], v9, s[48:51], s64 offen sc1
    s_mov_b32 s64, 483840
    buffer_load_dwordx2 v[56:57], v9, s[48:51], s64 offen sc1
    s_mov_b32 s64, 486144
    buffer_load_dwordx2 v[58:59], v9, s[48:51], s64 offen sc1
    s_mov_b32 s64, 488448
    buffer_load_dwordx2 v[60:61], v9, s[48:51], s64 offen sc1
    s_mov_b32 s64, 490752
    buffer_load_dwordx2 v[62:63], v9, s[48:51], s64 offen sc1
    s_mov_b32 s64, 493056
    buffer_load_dwordx2 v[64:65], v9, s[48:51], s64 offen sc1
    s_mov_b32 s64, 495360
    buffer_load_dwordx2 v[66:67], v9, s[48:51], s64 offen sc1
    s_mov_b32 s64, 497664
    buffer_load_dwordx2 v[68:69], v9, s[48:51], s64 offen sc1
    s_mov_b32 s64, 499968
    buffer_load_dwordx2 v[70:71], v9, s[48:51], s64 offen sc1
    s_mov_b32 s64, 502272
    buffer_load_dwordx2 v[72:73], v9, s[48:51], s64 offen sc1
    s_mov_b32 s64, 504576
    buffer_load_dwordx2 v[74:75], v9, s[48:51], s64 offen sc1
    v_mov_b32 v2, 0
    s_mov_b32 s64, 481536
    buffer_load_dword v116, v2, s[48:51], s64 offen sc1
    s_mov_b32 s64, 490752
    buffer_load_dword v117, v2, s[48:51], s64 offen sc1
    s_mov_b32 s64, 499968
    buffer_load_dword v118, v2, s[48:51], s64 offen sc1
    s_waitcnt vmcnt(0)
    v_max3_u32 v4, v52, v53, v54
    v_max3_u32 v5, v65, v66, v67
    v_max3_u32 v4, v4, v55, v56
    v_max3_u32 v5, v5, v68, v69
    v_max3_u32 v4, v4, v57, v58
    v_max3_u32 v5, v5, v70, v71
    v_max3_u32 v4, v4, v59, v60
    v_max3_u32 v5, v5, v72, v73
    v_max3_u32 v4, v4, v61, v62
    v_max3_u32 v5, v5, v74, v75
    v_max3_u32 v4, v4, v63, v64
    v_max3_u32 v5, v5, v116, v117
    v_max_u32 v5, v5, v118
    v_max_u32 v4, v4, v5
    v_cmp_eq_u32 vcc, -1, v4
    s_cmp_eq_u64 vcc, 0
    s_cbranch_scc1 L_E_okM
    s_sub_u32 s71, s71, 1
    s_cmp_lt_i32 s71, 0
    s_cbranch_scc1 L_E_okM
    s_sleep 6
    s_branch L_E_pollM
L_E_okM:
    v_add_f32 v4, v116, v117
    v_add_f32 v4, v4, v118
    v_lshlrev_b32 v12, 16, v12
    v_readfirstlane_b32 s15, v4
    v_readfirstlane_b32 s14, v12
    v_pk_add_f32 v[52:53], v[52:53], v[60:61]
    v_pk_add_f32 v[54:55], v[54:55], v[62:63]
    v_pk_add_f32 v[56:57], v[56:57], v[64:65]
    v_pk_add_f32 v[58:59], v[58:59], v[66:67]
    v_pk_add_f32 v[52:53], v[52:53], v[68:69]
    v_pk_add_f32 v[54:55], v[54:55], v[70:71]
    v_pk_add_f32 v[56:57], v[56:57], v[72:73]
    v_pk_add_f32 v[58:59], v[58:59], v[74:75]
    v_cvt_pk_bf16_f32 v52, 0, v52
    v_cvt_pk_bf16_f32 v53, 0, v53
    v_cvt_pk_bf16_f32 v54, 0, v54
    v_cvt_pk_bf16_f32 v55, 0, v55
    v_cvt_pk_bf16_f32 v56, 0, v56
    v_cvt_pk_bf16_f32 v57, 0, v57
    v_cvt_pk_bf16_f32 v58, 0, v58
    v_cvt_pk_bf16_f32 v59, 0, v59
    v_add_f32 v56, 1.0, v56
    v_add_f32 v57, 1.0, v57
    v_cvt_pk_bf16_f32 v56, 0, v56
    v_cvt_pk_bf16_f32 v57, 0, v57
    v_lshlrev_b32 v60, 16, v10
    v_and_b32 v61, 0xffff0000, v10
    ds_write_b64 v9, v[58:59] offset:38400
    s_movk_i32 s64, 288
    v_cmp_gt_u32 s[10:11], s64, v0
    v_and_b32 v2, 15, v1
    v_lshlrev_b32 v63, 4, v2
    v_cmp_gt_u32 vcc, 10, v2
    v_mov_b32 v3, 1.0
    s_nop 0
    v_cndmask_b32 v64, 0, v3, vcc
    v_min_u32 v63, 144, v63
    v_cndmask_b32 v65, 0, v3, s[10:11]
    s_mov_b64 s[60:61], s[40:41]
    s_mov_b64 s[16:17], -1
    s_mov_b64 s[18:19], -1
    s_mov_b64 s[20:21], -1
    s_mov_b64 s[22:23], -1
    s_mov_b64 s[24:25], -1
    s_mov_b64 s[26:27], -1
    s_mov_b64 s[28:29], -1
    s_mov_b64 s[30:31], -1
    s_mov_b64 s[32:33], -1
    s_mov_b64 s[34:35], -1
    s_mov_b64 s[36:37], -1
    s_mov_b64 s[38:39], -1
    s_mov_b64 s[40:41], -1
    s_mov_b64 s[42:43], -1
    s_mov_b64 s[44:45], -1
    s_mov_b64 s[46:47], -1
L_E_poll3:
    s_mov_b64 exec, s[16:17]
    s_cbranch_execz L_E_s0
    s_mov_b32 s64, 442368
    buffer_load_dwordx2 v[80:81], v9, s[48:51], s64 offen sc1
L_E_s0:
    s_mov_b64 exec, s[18:19]
    s_cbranch_execz L_E_s1
    s_mov_b32 s64, 444672
    buffer_load_dwordx2 v[82:83], v9, s[48:51], s64 offen sc1
L_E_s1:
    s_mov_b64 exec, s[20:21]
    s_cbranch_execz L_E_s2
    s_mov_b32 s64, 446976
    buffer_load_dwordx2 v[84:85], v9, s[48:51], s64 offen sc1
L_E_s2:
    s_mov_b64 exec, s[22:23]
    s_cbranch_execz L_E_s3
    s_mov_b32 s64, 449280
    buffer_load_dwordx2 v[86:87], v9, s[48:51], s64 offen sc1
L_E_s3:
    s_mov_b64 exec, s[24:25]
    s_cbranch_execz L_E_s4
    s_mov_b32 s64, 451584
    buffer_load_dwordx2 v[88:89], v9, s[48:51], s64 offen sc1
L_E_s4:
    s_mov_b64 exec, s[26:27]
    s_cbranch_execz L_E_s5
    s_mov_b32 s64, 453888
    buffer_load_dwordx2 v[90:91], v9, s[48:51], s64 offen sc1
L_E_s5:
    s_mov_b64 exec, s[28:29]
    s_cbranch_execz L_E_s6
    s_mov_b32 s64, 456192
    buffer_load_dwordx2 v[92:93], v9, s[48:51], s64 offen sc1
L_E_s6:
    s_mov_b64 exec, s[30:31]
    s_cbranch_execz L_E_s7
    s_mov_b32 s64, 458496
    buffer_load_dwordx2 v[94:95], v9, s[48:51], s64 offen sc1
L_E_s7:
    s_mov_b64 exec, s[32:33]
    s_cbranch_execz L_E_s8
    s_mov_b32 s64, 460800
    buffer_load_dwordx2 v[96:97], v9, s[48:51], s64 offen sc1
L_E_s8:
    s_mov_b64 exec, s[34:35]
    s_cbranch_execz L_E_s9
    s_mov_b32 s64, 463104
    buffer_load_dwordx2 v[98:99], v9, s[48:51], s64 offen sc1
L_E_s9:
    s_mov_b64 exec, s[36:37]
    s_cbranch_execz L_E_s10
    s_mov_b32 s64, 465408
    buffer_load_dwordx2 v[100:101], v9, s[48:51], s64 offen sc1
L_E_s10:
    s_mov_b64 exec, s[38:39]
    s_cbranch_execz L_E_s11
    s_mov_b32 s64, 467712
    buffer_load_dwordx2 v[102:103], v9, s[48:51], s64 offen sc1
L_E_s11:
    s_mov_b64 exec, s[40:41]
    s_cbranch_execz L_E_s12
    s_mov_b32 s64, 470016
    buffer_load_dwordx2 v[104:105], v9, s[48:51], s64 offen sc1
L_E_s12:
    s_mov_b64 exec, s[42:43]
    s_cbranch_execz L_E_s13
    s_mov_b32 s64, 472320
    buffer_load_dwordx2 v[106:107], v9, s[48:51], s64 offen sc1
L_E_s13:
    s_mov_b64 exec, s[44:45]
    s_cbranch_execz L_E_s14
    s_mov_b32 s64, 474624
    buffer_load_dwordx2 v[108:109], v9, s[48:51], s64 offen sc1
L_E_s14:
    s_mov_b64 exec, s[46:47]
    s_cbranch_execz L_E_s15
    s_mov_b32 s64, 476928
    buffer_load_dwordx2 v[110:111], v9, s[48:51], s64 offen sc1
L_E_s15:
L_E_pd:
    s_mov_b64 exec, -1
    s_waitcnt vmcnt(0)
    v_pk_add_f32 v[66:67], v[80:81], v[96:97]
    v_pk_add_f32 v[68:69], v[82:83], v[98:99]
    v_pk_add_f32 v[70:71], v[84:85], v[100:101]
    v_pk_add_f32 v[72:73], v[86:87], v[102:103]
    v_pk_add_f32 v[74:75], v[88:89], v[104:105]
    v_pk_add_f32 v[112:113], v[90:91], v[106:107]
    v_pk_add_f32 v[114:115], v[92:93], v[108:109]
    v_pk_add_f32 v[116:117], v[94:95], v[110:111]
    v_pk_add_f32 v[66:67], v[66:67], v[74:75]
    v_pk_add_f32 v[68:69], v[68:69], v[112:113]
    v_pk_add_f32 v[70:71], v[70:71], v[114:115]
    v_pk_add_f32 v[72:73], v[72:73], v[116:117]
    v_pk_add_f32 v[66:67], v[66:67], v[70:71]
    v_pk_add_f32 v[68:69], v[68:69], v[72:73]
    v_pk_add_f32 v[66:67], v[66:67], v[68:69]
    v_cmp_u_f32 vcc, v66, v67
    s_cmp_eq_u64 vcc, 0
    s_cbranch_scc1 L_E_ok3
    s_sub_u32 s71, s71, 1
    s_cmp_lt_i32 s71, 0
    s_cbranch_scc1 L_E_ok3
    v_max_u32 v4, v80, v81
    v_cmp_eq_u32 s[16:17], -1, v4
    v_max_u32 v5, v82, v83
    v_cmp_eq_u32 s[18:19], -1, v5
    v_max_u32 v4, v84, v85
    v_cmp_eq_u32 s[20:21], -1, v4
    v_max_u32 v5, v86, v87
    v_cmp_eq_u32 s[22:23], -1, v5
    v_max_u32 v4, v88, v89
    v_cmp_eq_u32 s[24:25], -1, v4
    v_max_u32 v5, v90, v91
    v_cmp_eq_u32 s[26:27], -1, v5
    v_max_u32 v4, v92, v93
    v_cmp_eq_u32 s[28:29], -1, v4
    v_max_u32 v5, v94, v95
    v_cmp_eq_u32 s[30:31], -1, v5
    v_max_u32 v4, v96, v97
    v_cmp_eq_u32 s[32:33], -1, v4
    v_max_u32 v5, v98, v99
    v_cmp_eq_u32 s[34:35], -1, v5
    v_max_u32 v4, v100, v101
    v_cmp_eq_u32 s[36:37], -1, v4
    v_max_u32 v5, v102, v103
    v_cmp_eq_u32 s[38:39], -1, v5
    v_max_u32 v4, v104, v105
    v_cmp_eq_u32 s[40:41], -1, v4
    v_max_u32 v5, v106, v107
    v_cmp_eq_u32 s[42:43], -1, v5
    v_max_u32 v4, v108, v109
    v_cmp_eq_u32 s[44:45], -1, v4
    v_max_u32 v5, v110, v111
    v_cmp_eq_u32 s[46:47], -1, v5
    s_mov_b64 vcc, s[16:17]
    s_or_b64 vcc, vcc, s[18:19]
    s_or_b64 vcc, vcc, s[20:21]
    s_or_b64 vcc, vcc, s[22:23]
    s_or_b64 vcc, vcc, s[24:25]
    s_or_b64 vcc, vcc, s[26:27]
    s_or_b64 vcc, vcc, s[28:29]
    s_or_b64 vcc, vcc, s[30:31]
    s_or_b64 vcc, vcc, s[32:33]
    s_or_b64 vcc, vcc, s[34:35]
    s_or_b64 vcc, vcc, s[36:37]
    s_or_b64 vcc, vcc, s[38:39]
    s_or_b64 vcc, vcc, s[40:41]
    s_or_b64 vcc, vcc, s[42:43]
    s_or_b64 vcc, vcc, s[44:45]
    s_or_b64 vcc, vcc, s[46:47]
    s_cmp_eq_u64 vcc, 0
    s_cbranch_scc0 L_E_poll3
L_E_ok3:
    s_mov_b64 s[40:41], s[60:61]
    v_cvt_pk_bf16_f32 v80, 0, v66
    v_cvt_pk_bf16_f32 v81, 0, v67
    v_mul_f32 v80, v80, v52
    v_mul_f32 v81, v81, v53
    v_cvt_pk_bf16_f32 v80, 0, v80
    v_cvt_pk_bf16_f32 v81, 0, v81
    v_add_f32 v82, v80, v60
    v_add_f32 v83, v81, v61
    v_cvt_pk_bf16_f32 v82, 0, v82
    v_cvt_pk_bf16_f32 v83, 0, v83
    ds_write_b64 v9, v[82:83] offset:36096
    v_subrev_f32 v4, s14, v82
    v_subrev_f32 v2, s14, v83
    v_mul_f32 v5, v4, v4
    v_add_f32 v4, v4, v2
    v_fmac_f32 v5, v2, v2
    v_mul_f32 v4, v4, v65
    v_mul_f32 v5, v5, v65
    s_nop 0
    v_add_f32_dpp v4, v4, v4 row_ror:1 row_mask:0xf bank_mask:0xf
    v_add_f32_dpp v5, v5, v5 row_ror:1 row_mask:0xf bank_mask:0xf
    s_nop 0
    v_add_f32_dpp v4, v4, v4 row_ror:2 row_mask:0xf bank_mask:0xf
    v_add_f32_dpp v5, v5, v5 row_ror:2 row_mask:0xf bank_mask:0xf
    s_nop 0
    v_add_f32_dpp v4, v4, v4 row_ror:4 row_mask:0xf bank_mask:0xf
    v_add_f32_dpp v5, v5, v5 row_ror:4 row_mask:0xf bank_mask:0xf
    s_nop 0
    v_add_f32_dpp v4, v4, v4 row_ror:8 row_mask:0xf bank_mask:0xf
    v_add_f32_dpp v5, v5, v5 row_ror:8 row_mask:0xf bank_mask:0xf
    v_min_u32 v5, 0xfffffffe, v5
    ds_write_b64 v13, v[4:5] offset:33280
L_E_r33280:
    ds_read_b128 v[92:95], v63 offset:33280
    s_waitcnt lgkmcnt(0)
    v_max_u32 v2, v93, v95
    v_pk_add_f32 v[4:5], v[92:93], v[94:95]
    v_cmp_eq_u32 vcc, -1, v2
    s_cmp_eq_u64 vcc, 0
    s_cbranch_scc1 L_E_k33280
    s_sub_u32 s71, s71, 1
    s_cmp_lt_i32 s71, 0
    s_cbranch_scc1 L_E_k33280
    s_branch L_E_r33280
L_E_k33280:
    v_pk_mul_f32 v[4:5], v[4:5], v[64:65] op_sel_hi:[1,0]
    s_nop 0
    s_nop 0
    v_add_f32_dpp v4, v4, v4 row_ror:1 row_mask:0xf bank_mask:0xf
    v_add_f32_dpp v5, v5, v5 row_ror:1 row_mask:0xf bank_mask:0xf
    s_nop 0
    v_add_f32_dpp v4, v4, v4 row_ror:2 row_mask:0xf bank_mask:0xf
    v_add_f32_dpp v5, v5, v5 row_ror:2 row_mask:0xf bank_mask:0xf
    s_nop 0
    v_add_f32_dpp v4, v4, v4 row_ror:4 row_mask:0xf bank_mask:0xf
    v_add_f32_dpp v5, v5, v5 row_ror:4 row_mask:0xf bank_mask:0xf
    s_nop 0
    v_add_f32_dpp v4, v4, v4 row_ror:8 row_mask:0xf bank_mask:0xf
    v_add_f32_dpp v5, v5, v5 row_ror:8 row_mask:0xf bank_mask:0xf
    v_mul_f32 v4, 0x3ae38e39, v4
    v_mul_f32 v5, 0x3ae38e39, v5
    v_fma_f32 v5, -v4, v4, v5
    v_add_f32 v6, s14, v4
    v_max_f32 v5, 0, v5
    v_cvt_pk_bf16_f32 v5, 0, v5
    v_cvt_pk_bf16_f32 v6, 0, v6
    v_add_f32 v5, 0x3727c5ac, v5
    v_cvt_pk_bf16_f32 v5, 0, v5
    v_sqrt_f32 v5, v5
    s_nop 0
    v_cvt_pk_bf16_f32 v5, 0, v5
    v_rcp_f32 v7, v5
    s_nop 0
    v_sub_f32 v84, v82, v6
    v_sub_f32 v85, v83, v6
    v_cvt_pk_bf16_f32 v84, 0, v84
    v_cvt_pk_bf16_f32 v85, 0, v85
    v_mul_f32 v84, v84, v7
    v_mul_f32 v85, v85, v7
    v_cvt_pk_bf16_f32 v84, 0, v84
    v_cvt_pk_bf16_f32 v85, 0, v85
    v_mul_f32 v84, v84, v56
    v_mul_f32 v85, v85, v57
    v_cvt_pk_bf16_f32 v84, 0, v84
    v_cvt_pk_bf16_f32 v85, 0, v85
    v_add_f32 v84, v84, v54
    v_add_f32 v85, v85, v55
    v_cvt_pk_bf16_f32 v84, 0, v84
    v_cvt_pk_bf16_f32 v85, 0, v85
    v_subrev_f32 v4, s15, v84
    v_subrev_f32 v2, s15, v85
    v_mul_f32 v5, v4, v4
    v_add_f32 v4, v4, v2
    v_fmac_f32 v5, v2, v2
    v_mul_f32 v4, v4, v65
    v_mul_f32 v5, v5, v65
    s_nop 0
    v_add_f32_dpp v4, v4, v4 row_ror:1 row_mask:0xf bank_mask:0xf
    v_add_f32_dpp v5, v5, v5 row_ror:1 row_mask:0xf bank_mask:0xf
    s_nop 0
    v_add_f32_dpp v4, v4, v4 row_ror:2 row_mask:0xf bank_mask:0xf
    v_add_f32_dpp v5, v5, v5 row_ror:2 row_mask:0xf bank_mask:0xf
    s_nop 0
    v_add_f32_dpp v4, v4, v4 row_ror:4 row_mask:0xf bank_mask:0xf
    v_add_f32_dpp v5, v5, v5 row_ror:4 row_mask:0xf bank_mask:0xf
    s_nop 0
    v_add_f32_dpp v4, v4, v4 row_ror:8 row_mask:0xf bank_mask:0xf
    v_add_f32_dpp v5, v5, v5 row_ror:8 row_mask:0xf bank_mask:0xf
    v_min_u32 v5, 0xfffffffe, v5
    ds_write_b64 v13, v[4:5] offset:33456
L_E_r33456:
    ds_read_b128 v[92:95], v63 offset:33456
    s_waitcnt lgkmcnt(0)
    v_max_u32 v2, v93, v95
    v_pk_add_f32 v[4:5], v[92:93], v[94:95]
    v_cmp_eq_u32 vcc, -1, v2
    s_cmp_eq_u64 vcc, 0
    s_cbranch_scc1 L_E_k33456
    s_sub_u32 s71, s71, 1
    s_cmp_lt_i32 s71, 0
    s_cbranch_scc1 L_E_k33456
    s_branch L_E_r33456
L_E_k33456:
    v_pk_mul_f32 v[4:5], v[4:5], v[64:65] op_sel_hi:[1,0]
    s_nop 0
    s_nop 0
    v_add_f32_dpp v4, v4, v4 row_ror:1 row_mask:0xf bank_mask:0xf
    v_add_f32_dpp v5, v5, v5 row_ror:1 row_mask:0xf bank_mask:0xf
    s_nop 0
    v_add_f32_dpp v4, v4, v4 row_ror:2 row_mask:0xf bank_mask:0xf
    v_add_f32_dpp v5, v5, v5 row_ror:2 row_mask:0xf bank_mask:0xf
    s_nop 0
    v_add_f32_dpp v4, v4, v4 row_ror:4 row_mask:0xf bank_mask:0xf
    v_add_f32_dpp v5, v5, v5 row_ror:4 row_mask:0xf bank_mask:0xf
    s_nop 0
    v_add_f32_dpp v4, v4, v4 row_ror:8 row_mask:0xf bank_mask:0xf
    v_add_f32_dpp v5, v5, v5 row_ror:8 row_mask:0xf bank_mask:0xf
    v_mul_f32 v4, 0x3ae38e39, v4
    v_mul_f32 v5, 0x3ae38e39, v5
    v_fma_f32 v5, -v4, v4, v5
    v_add_f32 v6, s15, v4
    v_max_f32 v5, 0, v5
    v_cvt_pk_bf16_f32 v5, 0, v5
    v_cvt_pk_bf16_f32 v6, 0, v6
    v_add_f32 v5, 0x3727c5ac, v5
    v_cvt_pk_bf16_f32 v5, 0, v5
    v_sqrt_f32 v5, v5
    s_nop 0
    v_cvt_pk_bf16_f32 v5, 0, v5
    v_rcp_f32 v7, v5
    s_nop 0
    v_sub_f32 v84, v84, v6
    v_sub_f32 v85, v85, v6
    v_cvt_pk_bf16_f32 v84, 0, v84
    v_cvt_pk_bf16_f32 v85, 0, v85
    v_mul_f32 v84, v84, v7
    v_mul_f32 v85, v85, v7
    v_cvt_pk_bf16_f32 v84, 0, v84
    v_cvt_pk_bf16_f32 v85, 0, v85
    v_bfe_u32 v86, v84, 23, 8
    v_bfe_u32 v87, v85, 23, 8
    v_bfe_u32 v88, v84, 16, 7
    v_bfe_u32 v89, v85, 16, 7
    v_subrev_u32 v86, 116, v86
    v_subrev_u32 v87, 116, v87
    v_lshrrev_b32 v90, 31, v84
    v_lshrrev_b32 v91, 31, v85
    v_cmp_le_u32 s[60:61], 14, v86
    v_cmp_le_u32 s[62:63], 14, v87
    v_min_u32 v86, 13, v86
    v_min_u32 v87, 13, v87
    v_mad_u32_u24 v86, v90, 14, v86
    v_mad_u32_u24 v87, v91, 14, v87
    v_cmp_le_u32 vcc, 14, v86
    v_cmp_le_u32 s[66:67], 14, v87
    v_lshl_add_u32 v88, v88, 5, v86
    v_lshl_add_u32 v89, v89, 5, v87
    v_add_u32 v90, 2, v88
    v_add_u32 v91, 2, v89
    v_cndmask_b32 v88, v88, v90, vcc
    v_cndmask_b32 v89, v89, v91, s[66:67]
    v_lshlrev_b32 v88, 2, v88
    v_lshlrev_b32 v89, 2, v89
    s_barrier
    ds_read_b32 v90, v88 offset:40960
    ds_read_b32 v91, v89 offset:40960
    v_lshrrev_b32 v2, 1, v9
    s_waitcnt lgkmcnt(0)
    v_cvt_pk_bf16_f32 v90, 0, v90
    v_cvt_pk_bf16_f32 v91, 0, v91
    v_add_f32 v90, v90, v8
    v_add_f32 v91, v91, v8
    v_cvt_pk_bf16_f32 v90, 0, v90
    v_cvt_pk_bf16_f32 v91, 0, v91
    v_mul_f32 v90, v90, v58
    v_mul_f32 v91, v91, v59
    v_cvt_pk_bf16_f32 v90, 0, v90
    v_cvt_pk_bf16_f32 v91, 0, v91
    v_add_f32 v90, v90, v82
    v_add_f32 v91, v91, v83
    v_cvt_pk_bf16_f32 v90, v90, v91
    s_andn2_b64 exec, s[10:11], s[60:61]
    s_cbranch_execz L_E_st1
    global_store_short v2, v90, s[40:41]
L_E_st1:
    s_andn2_b64 exec, s[10:11], s[62:63]
    s_cbranch_execz L_E_st2
    global_store_short_d16_hi v2, v90, s[40:41] offset:2
L_E_st2:
    s_mov_b64 exec, -1
    ds_write_b64 v9, v[84:85] offset:33792
    s_and_b64 s[60:61], s[60:61], s[10:11]
    s_and_b64 s[62:63], s[62:63], s[10:11]
    v_mov_b32 v92, s60
    v_mov_b32 v93, s61
    v_mov_b32 v94, s62
    v_mov_b32 v95, s63
    s_lshl_b32 s66, s3, 4
    v_mov_b32 v3, s66
    ds_write_b128 v3, v[92:95] offset:33632
    s_waitcnt lgkmcnt(0)
    s_branch L_E_b3
L_E_tb:
    s_barrier
    v_subrev_u32 v7, 320, v0
    v_lshlrev_b32 v9, 4, v7
    v_lshlrev_b32 v10, 3, v7
    v_add_u32 v6, 30720, v9
    v_min_u32 v6, 32752, v6
    v_lshrrev_b32 v5, 1, v6
    s_mov_b64 s[16:17], -1
    s_mov_b64 s[18:19], -1
    s_mov_b64 s[20:21], -1
    s_mov_b64 s[22:23], -1
    s_mov_b64 s[24:25], -1
    s_mov_b64 s[26:27], -1
    s_mov_b64 s[28:29], -1
    s_mov_b64 s[30:31], -1
    s_mov_b64 s[32:33], -1
    s_mov_b64 s[34:35], -1
    s_mov_b64 s[36:37], -1
L_E_tbpoll:
    s_mov_b64 exec, s[16:17]
    s_cbranch_execz L_E_t0
    s_mov_b32 s64, 524288
    buffer_load_dwordx4 v[52:55], v9, s[48:51], s64 offen sc1
L_E_t0:
    s_mov_b64 exec, s[18:19]
    s_cbranch_execz L_E_t1
    s_mov_b32 s64, 527360
    buffer_load_dwordx4 v[56:59], v9, s[48:51], s64 offen sc1
L_E_t1:
    s_mov_b64 exec, s[20:21]
    s_cbranch_execz L_E_t2
    s_mov_b32 s64, 530432
    buffer_load_dwordx4 v[60:63], v9, s[48:51], s64 offen sc1
L_E_t2:
    s_mov_b64 exec, s[22:23]
    s_cbranch_execz L_E_t3
    s_mov_b32 s64, 533504
    buffer_load_dwordx4 v[64:67], v9, s[48:51], s64 offen sc1
L_E_t3:
    s_mov_b64 exec, s[24:25]
    s_cbranch_execz L_E_t4
    s_mov_b32 s64, 536576
    buffer_load_dwordx4 v[68:71], v9, s[48:51], s64 offen sc1
L_E_t4:
    s_mov_b64 exec, s[26:27]
    s_cbranch_execz L_E_t5
    s_mov_b32 s64, 539648
    buffer_load_dwordx4 v[72:75], v9, s[48:51], s64 offen sc1
L_E_t5:
    s_mov_b64 exec, s[28:29]
    s_cbranch_execz L_E_t6
    s_mov_b32 s64, 542720
    buffer_load_dwordx4 v[76:79], v9, s[48:51], s64 offen sc1
L_E_t6:
    s_mov_b64 exec, s[30:31]
    s_cbranch_execz L_E_t7
    s_mov_b32 s64, 545792
    buffer_load_dwordx4 v[80:83], v9, s[48:51], s64 offen sc1
L_E_t7:
    s_mov_b64 exec, s[32:33]
    s_cbranch_execz L_E_t8
    s_mov_b32 s64, 548864
    buffer_load_dwordx4 v[84:87], v9, s[48:51], s64 offen sc1
L_E_t8:
    s_mov_b64 exec, s[34:35]
    s_cbranch_execz L_E_t9
    s_mov_b32 s64, 551936
    buffer_load_dwordx4 v[88:91], v9, s[48:51], s64 offen sc1
L_E_t9:
    s_mov_b64 exec, s[36:37]
    s_cbranch_execz L_E_t10
    s_mov_b32 s64, 524288
    buffer_load_dwordx4 v[92:95], v6, s[48:51], s64 offen sc1
L_E_t10:
    s_mov_b64 exec, -1
    s_waitcnt vmcnt(0)
    v_cmp_ne_u64 s[16:17], s[6:7], v[54:55]
    v_cmp_ne_u64 s[18:19], s[6:7], v[58:59]
    v_cmp_ne_u64 s[20:21], s[6:7], v[62:63]
    v_cmp_ne_u64 s[22:23], s[6:7], v[66:67]
    v_cmp_ne_u64 s[24:25], s[6:7], v[70:71]
    v_cmp_ne_u64 s[26:27], s[6:7], v[74:75]
    v_cmp_ne_u64 s[28:29], s[6:7], v[78:79]
    v_cmp_ne_u64 s[30:31], s[6:7], v[82:83]
    v_cmp_ne_u64 s[32:33], s[6:7], v[86:87]
    v_cmp_ne_u64 s[34:35], s[6:7], v[90:91]
    v_cmp_ne_u64 s[36:37], s[6:7], v[94:95]
    s_mov_b64 vcc, s[16:17]
    s_or_b64 vcc, vcc, s[18:19]
    s_or_b64 vcc, vcc, s[20:21]
    s_or_b64 vcc, vcc, s[22:23]
    s_or_b64 vcc, vcc, s[24:25]
    s_or_b64 vcc, vcc, s[26:27]
    s_or_b64 vcc, vcc, s[28:29]
    s_or_b64 vcc, vcc, s[30:31]
    s_or_b64 vcc, vcc, s[32:33]
    s_or_b64 vcc, vcc, s[34:35]
    s_or_b64 vcc, vcc, s[36:37]
    s_cmp_eq_u64 vcc, 0
    s_cbranch_scc1 L_E_tbok
    s_sub_u32 s71, s71, 1
    s_cmp_lt_i32 s71, 0
    s_cbranch_scc1 L_E_tbok
    s_sleep 3
    s_branch L_E_tbpoll
L_E_tbok:
    ds_write_b64 v10, v[52:53] offset:40960
    ds_write_b64 v10, v[56:57] offset:42496
    ds_write_b64 v10, v[60:61] offset:44032
    ds_write_b64 v10, v[64:65] offset:45568
    ds_write_b64 v10, v[68:69] offset:47104
    ds_write_b64 v10, v[72:73] offset:48640
    ds_write_b64 v10, v[76:77] offset:50176
    ds_write_b64 v10, v[80:81] offset:51712
    ds_write_b64 v10, v[84:85] offset:53248
    ds_write_b64 v10, v[88:89] offset:54784
    ds_write_b64 v5, v[92:93] offset:40960
    s_waitcnt lgkmcnt(0)
    s_barrier
L_E_b3:
    s_barrier
    v_and_b32 v2, 15, v1
    v_min_u32 v2, 9, v2
    v_lshlrev_b32 v2, 3, v2
    ds_read_b64 v[120:121], v2 offset:33632
    s_waitcnt lgkmcnt(0)
    v_cmp_ne_u64 vcc, 0, v[120:121]
    s_and_b32 s75, vcc_lo, 0x3ff
L_E_mk:
    s_cmp_eq_u32 s75, 0
    s_cbranch_scc1 L_fin
    s_ff1_i32_b32 s74, s75
    s_bitset0_b32 s75, s74
    v_readlane_b32 s60, v120, s74
    v_readlane_b32 s61, v121, s74
L_E_mbit:
    s_cmp_eq_u64 s[60:61], 0
    s_cbranch_scc1 L_E_mk
    s_ff1_i32_b64 s76, s[60:61]
    s_bitset0_b64 s[60:61], s76
    s_lshr_b32 s65, s74, 1
    s_lshl_b32 s65, s65, 6
    s_add_u32 s65, s65, s76
    s_lshl_b32 s65, s65, 1
    s_and_b32 s66, s74, 1
    s_add_u32 s65, s65, s66
    s_lshl_b32 s77, s65, 2
    v_mov_b32 v13, s77
    ds_read_b32 v4, v13 offset:33792
    ds_read_b32 v6, v13 offset:36096
    ds_read_b32 v7, v13 offset:38400
    s_mov_b32 s8, 1.0
    v_mov_b32 v80, 0
    v_mov_b32 v81, 0
    s_waitcnt lgkmcnt(0)
    v_readfirstlane_b32 s65, v4
    s_nop 1
    v_mul_f32 v42, s65, v16
    v_mul_f32 v43, s65, v17
    v_mul_f32 v44, s65, v18
    v_mul_f32 v45, s65, v19
    v_mul_f32 v46, s65, v20
    v_mul_f32 v47, s65, v21
    v_mul_f32 v48, s65, v22
    v_mul_f32 v49, s65, v23
    v_mul_f32 v50, s65, v24
    v_cvt_pk_bf16_f32 v42, 0, v42
    v_cvt_pk_bf16_f32 v43, 0, v43
    v_cvt_pk_bf16_f32 v44, 0, v44
    v_cvt_pk_bf16_f32 v45, 0, v45
    v_cvt_pk_bf16_f32 v46, 0, v46
    v_cvt_pk_bf16_f32 v47, 0, v47
    v_cvt_pk_bf16_f32 v48, 0, v48
    v_cvt_pk_bf16_f32 v49, 0, v49
    v_cvt_pk_bf16_f32 v50, 0, v50
    v_pk_fma_f32 v[52:53], v[42:43], s[8:9], v[26:27] op_sel_hi:[1,0,1]
    v_pk_fma_f32 v[54:55], v[44:45], s[8:9], v[28:29] op_sel_hi:[1,0,1]
    v_pk_fma_f32 v[56:57], v[46:47], s[8:9], v[30:31] op_sel_hi:[1,0,1]
    v_pk_fma_f32 v[58:59], v[48:49], s[8:9], v[32:33] op_sel_hi:[1,0,1]
    v_fma_f32 v60, v50, s8, v34
    v_cvt_pk_bf16_f32 v52, 0, v52
    v_cvt_pk_bf16_f32 v53, 0, v53
    v_cvt_pk_bf16_f32 v54, 0, v54
    v_cvt_pk_bf16_f32 v55, 0, v55
    v_cvt_pk_bf16_f32 v56, 0, v56
    v_cvt_pk_bf16_f32 v57, 0, v57
    v_cvt_pk_bf16_f32 v58, 0, v58
    v_cvt_pk_bf16_f32 v59, 0, v59
    v_cvt_pk_bf16_f32 v60, 0, v60
    v_pk_mul_f32 v[62:63], v[52:53], v[52:53]
    v_pk_mul_f32 v[64:65], v[54:55], v[54:55]
    v_pk_mul_f32 v[66:67], v[56:57], v[56:57]
    v_pk_mul_f32 v[68:69], v[58:59], v[58:59]
    v_mul_f32 v70, v60, v60
    v_pk_fma_f32 v[62:63], v[62:63], v[124:125], v[126:127]
    v_pk_fma_f32 v[64:65], v[64:65], v[124:125], v[126:127]
    v_pk_fma_f32 v[66:67], v[66:67], v[124:125], v[126:127]
    v_pk_fma_f32 v[68:69], v[68:69], v[124:125], v[126:127]
    v_fma_f32 v70, v70, v124, v126
    v_pk_mul_f32 v[62:63], v[62:63], v[52:53]
    v_pk_mul_f32 v[64:65], v[64:65], v[54:55]
    v_pk_mul_f32 v[66:67], v[66:67], v[56:57]
    v_pk_mul_f32 v[68:69], v[68:69], v[58:59]
    v_mul_f32 v70, v70, v60
    v_exp_f32 v62, v62
    v_exp_f32 v63, v63
    v_exp_f32 v64, v64
    v_exp_f32 v65, v65
    v_exp_f32 v66, v66
    v_exp_f32 v67, v67
    v_exp_f32 v68, v68
    v_exp_f32 v69, v69
    v_exp_f32 v70, v70
    v_pk_add_f32 v[62:63], v[62:63], 1.0 op_sel_hi:[1,0]
    v_pk_add_f32 v[64:65], v[64:65], 1.0 op_sel_hi:[1,0]
    v_pk_add_f32 v[66:67], v[66:67], 1.0 op_sel_hi:[1,0]
    v_pk_add_f32 v[68:69], v[68:69], 1.0 op_sel_hi:[1,0]
    v_add_f32 v70, 1.0, v70
    v_rcp_f32 v62, v62
    v_rcp_f32 v63, v63
    v_rcp_f32 v64, v64
    v_rcp_f32 v65, v65
    v_rcp_f32 v66, v66
    v_rcp_f32 v67, v67
    v_rcp_f32 v68, v68
    v_rcp_f32 v69, v69
    v_rcp_f32 v70, v70
    v_pk_mul_f32 v[62:63], v[62:63], v[52:53]
    v_pk_mul_f32 v[64:65], v[64:65], v[54:55]
    v_pk_mul_f32 v[66:67], v[66:67], v[56:57]
    v_pk_mul_f32 v[68:69], v[68:69], v[58:59]
    v_mul_f32 v70, v70, v60
    v_cvt_pk_bf16_f32 v72, v62, v63
    v_cvt_pk_bf16_f32 v73, v64, v65
    v_cvt_pk_bf16_f32 v74, v66, v67
    v_cvt_pk_bf16_f32 v75, v68, v69
    v_cvt_pk_bf16_f32 v76, v70, 0
    v_dot2c_f32_bf16 v80, v72, v36
    v_dot2c_f32_bf16 v80, v73, v37
    v_dot2c_f32_bf16 v80, v74, v38
    v_dot2c_f32_bf16 v80, v75, v39
    v_dot2c_f32_bf16 v80, v76, v40
    s_nop 2
    s_nop 0
    v_add_f32_dpp v80, v80, v80 row_ror:1 row_mask:0xf bank_mask:0xf
    v_add_f32_dpp v81, v81, v81 row_ror:1 row_mask:0xf bank_mask:0xf
    s_nop 0
    v_add_f32_dpp v80, v80, v80 row_ror:2 row_mask:0xf bank_mask:0xf
    v_add_f32_dpp v81, v81, v81 row_ror:2 row_mask:0xf bank_mask:0xf
    s_nop 0
    v_add_f32_dpp v80, v80, v80 row_ror:4 row_mask:0xf bank_mask:0xf
    v_add_f32_dpp v81, v81, v81 row_ror:4 row_mask:0xf bank_mask:0xf
    s_nop 0
    v_add_f32_dpp v80, v80, v80 row_ror:8 row_mask:0xf bank_mask:0xf
    v_add_f32_dpp v81, v81, v81 row_ror:8 row_mask:0xf bank_mask:0xf
    v_mov_b32 v2, v80
    v_mov_b32 v3, v81
    s_nop 0
    v_permlane16_swap_b32 v80, v2
    v_permlane16_swap_b32 v81, v3
    s_nop 0
    v_add_f32 v80, v80, v2
    v_add_f32 v81, v81, v3
    v_mov_b32 v2, v80
    v_mov_b32 v3, v81
    s_nop 0
    v_permlane32_swap_b32 v80, v2
    v_permlane32_swap_b32 v81, v3
    s_nop 0
    v_add_f32 v80, v80, v2
    v_add_f32 v81, v81, v3
    s_lshl_b32 s66, s3, 2
    v_mov_b32 v2, s66
    ds_write_b32 v2, v80 offset:33728
    s_waitcnt lgkmcnt(0)
    s_barrier
    v_mov_b32 v2, 0
    ds_read_b128 v[62:65], v2 offset:33728
    ds_read_b128 v[66:69], v2 offset:33744
    s_waitcnt lgkmcnt(0)
    s_barrier
    s_cmp_eq_u32 s3, 0
    s_cbranch_scc0 L_E_mbit
    v_add_f32 v62, v62, v63
    v_add_f32 v64, v64, v65
    v_add_f32 v66, v66, v67
    v_add_f32 v68, v68, v69
    v_add_f32 v62, v62, v64
    v_add_f32 v66, v66, v68
    v_add_f32 v62, v62, v66
    v_cvt_pk_bf16_f32 v62, 0, v62
    v_add_f32 v62, v62, v8
    v_cvt_pk_bf16_f32 v62, 0, v62
    v_mul_f32 v62, v62, v7
    v_cvt_pk_bf16_f32 v62, 0, v62
    v_add_f32 v62, v62, v6
    v_cvt_pk_bf16_f32 v62, v62, v62
    v_lshrrev_b32 v2, 1, v13
    s_mov_b64 exec, 1
    global_store_short v2, v62, s[40:41]
    s_mov_b64 exec, -1
    s_branch L_E_mbit
L_fin_done:
L_fin:
L_end:
    s_endpgm
L_codeend:
.section .rodata,"a"
.p2align 6
.amdhsa_kernel adaLN_cond__sliding_block_cached__mixer_token_mlp__decode_kernel
  .amdhsa_next_free_vgpr 128
  .amdhsa_next_free_sgpr 102
  .amdhsa_accum_offset 128
  .amdhsa_group_segment_fixed_size 0
  .amdhsa_kernarg_size 120
  .amdhsa_user_sgpr_count 2
  .amdhsa_user_sgpr_kernarg_segment_ptr 1
  .amdhsa_system_sgpr_workgroup_id_x 1
  .amdhsa_float_denorm_mode_32 3
.end_amdhsa_kernel
```
